```python
import torch

def _softmax(x, axis=-1):
    return torch.softmax(x, dim=axis)
def _gelu(x):
    return torch.nn.functional.gelu(x, approximate="tanh")
def _silu(x):
    return torch.nn.functional.silu(x)
def _sigmoid(x):
    return torch.sigmoid(x)
def _layernorm(x, axis=-1, eps=1e-5):
    m = x.mean(dim=axis, keepdim=True)
    v = x.var(dim=axis, keepdim=True, unbiased=False)
    return (x - m) / torch.sqrt(v + eps)
def _scatter_add(tgt, idx, src, axis=0):
    return tgt.clone().index_add_(axis, idx, src)
def _segment_sum(src, seg, n):
    out = torch.zeros((n,) + src.shape[1:], dtype=src.dtype)
    return out.index_add_(0, seg, src)
def _pad(x, pw):
    flat = tuple(v for pair in reversed(pw) for v in pair)
    return torch.nn.functional.pad(x, flat)

kernel_name = 'parallel_sum__ssm_conv_s4d__moe_arch_mod__prompt'

def setup_inputs():

    _w = (lambda a: (lambda t: t.to(torch.bfloat16) if t.is_floating_point() else t)(torch.as_tensor(a)))
    def _A_setup():
        Bsz, L, D, N = 1, 2048, 448, 256
        return {
            "u": _w((lambda *s: torch.randn(*s, dtype=torch.bfloat16) * 0.05)(Bsz, L, D)),
            "log_A_real": _w((lambda *s: torch.randn(*s, dtype=torch.bfloat16) * 3.2)(D, N) * 0.5),
            "A_imag": _w((lambda *s: torch.randn(*s, dtype=torch.bfloat16) * 0.1)(D, N) * 3.14),
            "C_real": _w((lambda *s: torch.randn(*s, dtype=torch.bfloat16) * 1.6)(D, N) / N ** 0.5),
            "C_imag": _w((lambda *s: torch.randn(*s, dtype=torch.bfloat16) * 1.6)(D, N) / N ** 0.5),
            "log_dt": _w((lambda *s: torch.randn(*s, dtype=torch.bfloat16) * 0.1)(D) * 0.5 - 4.0),
            "D_skip": _w((lambda *s: torch.randn(*s, dtype=torch.bfloat16) * 0.1)(D)),
        }
    _A_in = _A_setup()

    def _B_setup():
        B, S, D, F, C = 1, 2048, 448, 1792, 1
        return {
            "x": _w((lambda *s: torch.randn(*s, dtype=torch.bfloat16) * 0.05)(B, S, D)),
            "w_r": _w((lambda *s: torch.randn(*s, dtype=torch.bfloat16) * 0.05)(D)),
            "w_gate": _w((lambda *s: torch.randn(*s, dtype=torch.bfloat16) * 0.05)(D, F)),
            "w_up": _w((lambda *s: torch.randn(*s, dtype=torch.bfloat16) * 0.05)(D, F)),
            "w_down": _w((lambda *s: torch.randn(*s, dtype=torch.bfloat16) * 0.05)(F, D)),
        }
    _B_in = _B_setup()

    return {
        "A_u": _A_in["u"],
        "A_log_A_real": _A_in["log_A_real"],
        "A_A_imag": _A_in["A_imag"],
        "A_C_real": _A_in["C_real"],
        "A_C_imag": _A_in["C_imag"],
        "A_log_dt": _A_in["log_dt"],
        "A_D_skip": _A_in["D_skip"],
        "B_x": _B_in["x"],
        "B_w_r": _B_in["w_r"],
        "B_w_gate": _B_in["w_gate"],
        "B_w_up": _B_in["w_up"],
        "B_w_down": _B_in["w_down"],
    }

def reference(A_u, A_log_A_real, A_A_imag, A_C_real, A_C_imag, A_log_dt, A_D_skip, B_x, B_w_r, B_w_gate, B_w_up, B_w_down):
    def _A_ref(u, log_A_real, A_imag, C_real, C_imag, log_dt, D_skip):
        L = u.shape[1]
        dt = torch.exp(log_dt)
        A = -torch.exp(log_A_real) + 1j * A_imag
        C = (C_real + 1j * C_imag) * dt[:, None]
        pos = (lambda x, dt: x.to(dt))(torch.arange(L), log_dt.dtype)
        P = torch.exp((A * dt[:, None])[:, :, None] * pos[None, None, :])
        K = 2.0 * torch.einsum("dn,dnl->dl", C, P).real
        L2 = 2 * L
        u_t = (lambda x, *d: x.permute(*d))(u, 0, 2, 1)
        Kf = (lambda x, *a, **k: torch.fft.rfft(x.float(), *a, **k))(K, L2)
        Uf = (lambda x, *a, **k: torch.fft.rfft(x.float(), *a, **k))(u_t, L2)
        y = (lambda x, *a, **k: torch.fft.irfft(x, *a, **k).to(torch.bfloat16))(Uf * Kf[None, :, :], L2)[:, :, :L]
        y = (lambda x, *d: x.permute(*d))(y, 0, 2, 1)
        return y + u * D_skip[None, None, :]

    def _B_ref(x, w_r, w_gate, w_up, w_down):
        B, S, D = x.shape
        C = 1
        r = x @ w_r
        idx = torch.argsort(-r, axis=-1)[:, :C]
        idx_e = (lambda x, n, axis: torch.repeat_interleave(x, n, dim=axis))(idx.reshape(B, C, 1), D, axis=2)
        x_sel = (lambda x, i, axis: torch.take_along_dim(x, i, dim=axis))(x, idx_e, axis=1)
        g = _silu(x_sel @ w_gate)
        u = x_sel @ w_up
        y = (g * u) @ w_down
        r_sel = _sigmoid((lambda x, i, axis: torch.take_along_dim(x, i, dim=axis))(r, idx, axis=1))
        y = y * r_sel.reshape(B, C, 1)
        b_off = (torch.arange(B) * S).reshape(B, 1)
        flat_idx = (idx + b_off).reshape(B * C)
        zero = (x * 0.0).reshape(B * S, D)
        upd = _scatter_add(zero, flat_idx, y.reshape(B * C, D), axis=0)
        return x + upd.reshape(B, S, D)

    x = A_u
    xn = _layernorm(x, axis=-1)
    return x + _A_ref(xn, A_log_A_real, A_A_imag, A_C_real, A_C_imag, A_log_dt, A_D_skip) + _B_ref(xn, B_w_r, B_w_gate, B_w_up, B_w_down)
```

```asm
; @launch grid=(252,1,1) block=(1024,1,1) lds=143424
.amdgcn_target "amdgcn-amd-amdhsa--gfx950"
.text
.globl parallel_sum__ssm_conv_s4d__moe_arch_mod__prompt_kernel
.p2align 8
.type parallel_sum__ssm_conv_s4d__moe_arch_mod__prompt_kernel,@function
parallel_sum__ssm_conv_s4d__moe_arch_mod__prompt_kernel:
    v_lshrrev_b32 v2, 6, v0
    v_and_b32 v1, 63, v0
    s_and_b32 s43, s2, 7
    v_readfirstlane_b32 s40, v2
    s_lshr_b32 s44, s2, 3
    s_mul_i32 s41, s43, 28
    s_add_u32 s41, s41, s44
    s_lshl_b32 s48, s41, 2
    s_cmp_ge_u32 s44, 28
    s_cselect_b32 s45, 0, s40
    s_cmp_lt_u32 s45, 8
    s_cbranch_scc1 L_xf
    s_load_dwordx8 s[4:11], s[0:1], 8
    s_load_dwordx2 s[14:15], s[0:1], 40
    s_setprio 3
    s_lshl_b32 s47, s41, 10
    s_sub_u32 s47, s47, 1024
    v_lshl_add_u32 v6, v0, 1, s47
    v_mov_b32 v16, 0
    v_mov_b32 v17, 0
    v_mov_b32 v18, 0
    v_mov_b32 v19, 0
    s_mov_b32 s38, 229376
    s_mov_b32 s39, 0x20000
    s_mov_b64 s[58:59], s[38:39]
    s_waitcnt lgkmcnt(0)
    s_load_dword s54, s[14:15], s48
    s_mov_b64 s[36:37], s[6:7]
    s_mov_b64 s[6:7], s[38:39]
    buffer_load_short_d16_hi v16, v6, s[4:7], 0 offen
    buffer_load_short_d16_hi v17, v6, s[36:39], 0 offen
    s_mov_b64 s[56:57], s[10:11]
    s_mov_b64 s[10:11], s[38:39]
    buffer_load_short_d16_hi v18, v6, s[8:11], 0 offen
    buffer_load_short_d16_hi v19, v6, s[56:59], 0 offen
    s_branch L_kw
L_xf:
    s_load_dwordx2 s[4:5], s[0:1], 0
    s_load_dwordx8 s[20:27], s[0:1], 64
    s_load_dwordx2 s[34:35], s[0:1], 112
    s_mov_b32 s6, 1835008
    s_mov_b32 s7, 0x20000
    s_cmp_ge_u32 s44, 28
    s_cbranch_scc1 L_ffn
    s_setprio 2
    s_mov_b32 s38, 16777216
    s_mov_b32 s39, s7
    v_mov_b32 v51, 0
    s_mul_i32 s45, s40, 28
    s_add_u32 s45, s45, s44
    s_cmp_ge_u32 s40, 4
    s_cbranch_scc1 L_x_tile0
    s_cmp_lt_u32 s40, 2
    s_cbranch_scc1 L_x_nocpf
    s_getpc_b64 s[12:13]
L_cpf_base:
    v_and_b32 v3, 127, v0
    v_lshlrev_b32 v3, 7, v3
    v_min_u32 v3, L_exit-L_cpf_base, v3
    v_mov_b32 v5, s13
    v_add_co_u32 v4, vcc, s12, v3
    s_nop 1
    v_addc_co_u32 v5, vcc, 0, v5, vcc
    global_load_dword v106, v[4:5], off
L_x_nocpf:
    s_lshl_b32 s47, s43, 6
    s_add_u32 s47, s47, s45
    s_mul_i32 s46, s47, 3584
    v_lshlrev_b32 v99, 4, v1
    v_lshrrev_b32 v58, 4, v1
    v_and_b32 v98, 0xf0, v99
    v_cmp_gt_u32 vcc, 0x80, v98
    v_mul_u32_u24 v96, 896, v58
    v_bfrev_b32 v97, -4
    v_add_u32 v96, v96, v98
    v_cndmask_b32 v97, v97, v96, vcc
    s_movk_i32 s10, 896
    s_mov_b32 s11, s7
    s_lshl_b32 s15, s47, 4
    s_add_u32 s15, s15, 4096
    s_lshl_b32 s18, s47, 3
    s_add_u32 s18, s18, 20480
    v_and_b32 v100, 32, v1
    v_lshlrev_b32 v100, 8, v100
    s_cmp_ge_u32 s45, 64
    s_waitcnt lgkmcnt(0)
    s_load_dword s42, s[34:35], 0
    s_mov_b64 s[36:37], s[34:35]
    s_cbranch_scc1 L_x_join0
    buffer_load_dwordx4 v[32:35], v96, s[4:7], s46 offen
    buffer_load_dwordx4 v[36:39], v96, s[4:7], s46 offen offset:256
    buffer_load_dwordx4 v[40:43], v96, s[4:7], s46 offen offset:512
    buffer_load_dwordx4 v[44:47], v97, s[4:7], s46 offen offset:768
    s_mov_b64 s[8:9], s[20:21]
    buffer_load_dwordx4 v[80:83], v99, s[8:11], 0 offen
    buffer_load_dwordx4 v[64:67], v98, s[8:11], 0 offen
    buffer_load_dwordx4 v[68:71], v98, s[8:11], 0 offen offset:256
    buffer_load_dwordx4 v[72:75], v98, s[8:11], 0 offen offset:512
    buffer_load_dwordx4 v[76:79], v98, s[8:11], 0 offen offset:768
    s_brev_b32 exec_lo, 1
    s_brev_b32 exec_hi, 1
    buffer_store_dwordx4 v[48:51], v100, s[36:39], s15 offen sc1
    s_mov_b32 exec_lo, 0
    buffer_store_dwordx2 v[50:51], off, s[36:39], s18 sc1
    s_mov_b64 exec, -1
    s_branch L_x_join0
L_x_tile0:
    v_and_b32 v98, 3, v1
    v_bfe_u32 v99, v1, 4, 1
    v_lshl_add_u32 v98, v99, 2, v98
    v_bfe_u32 v99, v1, 2, 2
    v_bfe_u32 v96, v0, 5, 3
    v_lshl_add_u32 v99, v96, 2, v99
    v_mul_u32_u24 v96, 3584, v98
    v_lshl_add_u32 v96, v99, 2, v96
    s_mul_i32 s49, s44, 37
    s_lshr_b32 s49, s49, 8
    s_mul_i32 s50, s49, 7
    s_sub_u32 s50, s44, s50
    s_lshl_b32 s12, s43, 2
    s_add_u32 s49, s49, s12
    s_mul_i32 s12, s49, 57344
    s_lshl_b32 s13, s50, 7
    s_add_u32 s12, s12, s13
    s_add_u32 s13, s12, 28672
    s_waitcnt lgkmcnt(0)
    s_load_dword s42, s[34:35], 0
    buffer_load_dword v64, v96, s[4:7], s12 offen offset:0
    buffer_load_dword v65, v96, s[4:7], s12 offen offset:896
    buffer_load_dword v66, v96, s[4:7], s12 offen offset:1792
    buffer_load_dword v72, v96, s[4:7], s12 offen offset:2688
    buffer_load_dword v68, v96, s[4:7], s13 offen offset:0
    buffer_load_dword v69, v96, s[4:7], s13 offen offset:896
    buffer_load_dword v70, v96, s[4:7], s13 offen offset:1792
    buffer_load_dword v73, v96, s[4:7], s13 offen offset:2688
    s_mov_b64 s[36:37], s[34:35]
    v_mul_u32_u24 v100, 12416, v99
    v_lshl_add_u32 v100, v98, 4, v100
    s_mul_i32 s15, s50, 397312
    s_mul_i32 s49, s49, 384
    s_add_u32 s15, s15, s49
    s_add_u32 s15, s15, 262144
L_x_join0:
    s_load_dwordx2 s[16:17], s[0:1], 48
    s_load_dwordx2 s[28:29], s[0:1], 96
    s_mov_b64 s[30:31], s[6:7]
    v_mov_b32 v48, 0
    v_mov_b32 v49, 0
    v_mov_b32 v50, 0
    v_lshrrev_b32 v11, 4, v0
    v_mul_u32_u24 v11, 384, v11
    v_and_b32 v12, 7, v0
    v_lshl_add_u32 v12, v12, 4, v11
    v_and_b32 v5, 15, v0
    v_lshl_add_u32 v11, v5, 4, v11
    v_cmp_lt_u32 s[56:57], 7, v5
    v_lshrrev_b32 v8, 2, v5
    v_lshrrev_b32 v4, 4, v1
    v_cmp_eq_u32 vcc, v8, v4
    v_lshlrev_b32 v13, 4, v0
    v_mov_b32 v9, 0x3f80
    v_lshlrev_b32 v8, v13, v9
    v_cndmask_b32 v8, 0, v8, vcc
    v_and_b32 v9, 2, v1
    v_cmp_eq_u32 vcc, 0, v9
    v_lshlrev_b32 v7, 3, v0
    v_sub_u32 v7, 121592, v7
    v_cndmask_b32 v28, 0, v8, vcc
    v_sub_u32 v29, v8, v28
    v_mov_b32 v30, v28
    v_mov_b32 v31, v29
    v_and_b32 v26, 3, v1
    v_lshrrev_b32 v27, 2, v1
    v_lshl_add_u32 v24, v26, 4, v27
    v_lshl_add_u32 v24, v9, 2, v24
    s_mul_i32 s49, s40, 4608
    v_lshl_add_u32 v24, v24, 3, s49
    s_mul_i32 s60, s41, 4682
    s_lshr_b32 s60, s60, 16
    s_mul_i32 s61, s60, 14
    s_sub_u32 s61, s41, s61
    s_lshl_b32 s62, s40, 4
    s_add_u32 s62, s62, s60
    s_mul_i32 s33, s62, 14336
    s_lshl_b32 s32, s61, 6
    s_add_u32 s33, s33, s32
    s_lshr_b32 s63, s62, 2
    s_mul_i32 s63, s63, 384
    s_mul_i32 s32, s61, 198656
    s_add_u32 s63, s63, s32
    s_add_u32 s63, s63, 262144
    s_and_b32 s32, s60, 1
    s_lshl_b32 s32, s32, 6
    s_add_u32 s32, s32, s63
    s_and_b32 s59, s60, 3
    s_lshl_b32 s59, s59, 6
    s_add_u32 s63, s63, s59
    s_lshl_b32 s62, s62, 4
    s_mul_i32 s59, s40, 1280
    s_add_u32 s59, s59, 40960
    v_mul_u32_u24 v6, 12416, v27
    v_lshl_add_u32 v6, v26, 4, v6
    v_lshl_add_u32 v9, v27, 2, v27
    v_add_lshl_u32 v9, v9, v26, 4
    v_add_u32 v9, s59, v9
    v_lshl_add_u32 v10, v5, 2, v5
    v_add_lshl_u32 v10, v10, v4, 4
    v_add_u32 v10, s59, v10
    v_mul_u32_u24 v3, 3584, v4
    v_lshl_add_u32 v3, v5, 2, v3
    v_lshl_add_u32 v4, v4, 2, s62
    v_mul_u32_u24 v8, 3712, v1
    s_and_b32 s54, s41, 0xe0
    s_bfe_u32 s59, s41, 0x30002
    s_add_u32 s54, s54, s59
    s_and_b32 s59, s41, 3
    s_lshl3_add_u32 s54, s59, s54
    s_lshl_b32 s54, s54, 4
    s_add_u32 s54, s54, 32768
    v_mov_b32 v92, 0
    v_mov_b32 v93, 0
    v_mov_b32 v95, 0
    s_mul_i32 s51, s41, 12416
    s_add_u32 s51, s51, 262144
    s_movk_i32 s52, 4096
    s_movk_i32 s53, 12288
    s_lshl_b32 s59, s40, 2
    s_add_u32 s59, s59, 143360
    v_mov_b32 v5, s59
    s_waitcnt lgkmcnt(0)
    s_mul_i32 s42, s42, 0x9e3779b1
    s_add_u32 s42, s42, 0x7f4a7c15
    s_bitset1_b32 s42, 0
    v_mov_b32 v55, s42
    s_not_b32 s58, s42
    ds_write_b32 v5, v55
    v_mov_b32 v87, s58
    v_mov_b32 v91, s58
    v_bfrev_b32 v101, -2
    v_bfrev_b32 v102, -2
    s_cmp_lg_u32 s40, 0
    s_cbranch_scc1 L_x_nopfa
    s_lshl_b32 s49, s44, 4
    v_add_u32 v27, s49, v27
    s_lshr_b32 s49, s43, 2
    s_sub_u32 s49, 4, s49
    v_cmp_gt_u32 vcc, s49, v26
    s_min_u32 s49, s43, 4
    s_mul_i32 s50, s43, 3
    s_add_u32 s49, s49, s50
    v_add_u32 v26, s49, v26
    v_mul_u32_u24 v5, 3584, v27
    v_lshl_add_u32 v5, v26, 7, v5
    v_mul_u32_u24 v26, 57344, v26
    v_lshl_add_u32 v26, v27, 7, v26
    v_cndmask_b32 v101, v101, v5, vcc
    v_cndmask_b32 v102, v102, v26, vcc
L_x_nopfa:
    s_cmp_ge_u32 s40, 4
    s_cbranch_scc1 L_x_tile1
    s_cmp_lg_u32 s40, 3
    s_cbranch_scc1 L_x_nopad
    v_and_b32 v107, 3, v1
    v_lshrrev_b32 v108, 2, v1
    s_mul_i32 s49, s44, 14
    s_add_u32 s49, s49, 56
    v_add_u32 v108, s49, v108
    s_lshr_b32 s49, s43, 2
    s_sub_u32 s49, 4, s49
    v_cmp_gt_u32 vcc, s49, v107
    s_min_u32 s49, s43, 4
    s_mul_i32 s50, s43, 3
    s_add_u32 s49, s49, s50
    v_add_u32 v107, s49, v107
    v_mul_u32_u24 v108, 3584, v108
    v_lshl_add_u32 v108, v107, 7, v108
    s_mov_b64 s[8:9], s[22:23]
    s_mov_b32 s10, 1605632
    s_mov_b32 s11, 0x20000
    s_mov_b64 s[12:13], s[24:25]
    s_mov_b64 s[14:15], s[10:11]
    s_mov_b32 exec_lo, vcc_lo
    s_and_b32 exec_hi, vcc_hi, 0xffffff
    buffer_load_dword v109, v108, s[8:11], 0 offen
    buffer_load_dword v110, v108, s[12:15], 0 offen
    s_mov_b64 exec, -1
    v_lshrrev_b32 v5, 5, v1
    v_mul_u32_u24 v5, 4064, v5
    v_add_u32 v5, v5, v99
    v_add_u32 v5, 121600, v5
    v_lshrrev_b32 v26, 1, v1
    v_mul_u32_u24 v26, 4128, v26
    v_add_u32 v26, v26, v99
    v_add_u32 v26, 126720, v26
    s_mov_b32 exec_lo, 0x3fffffff
    s_mov_b32 exec_hi, 0x3fffffff
    ds_write_b128 v5, v[48:51]
    s_mov_b64 exec, 0xff
    ds_write_b128 v26, v[48:51]
    s_mov_b64 exec, -1
L_x_nopad:
    s_cmp_ge_u32 s45, 64
    s_cbranch_scc1 L_x_pub
    v_mov_b32 v57, s42
    s_lshl_b32 s49, s47, 2
    s_sub_u32 s49, 2047, s49
    v_sub_u32 v58, s49, v58
    s_mov_b32 s50, 0xffff0000
    s_mov_b32 s49, 0x3f803f80
    s_cmp_lg_u32 s40, 0
    s_cbranch_scc1 L_x_hsd
    v_and_b32 v5, 7, v1
    v_lshlrev_b32 v5, 2, v5
    v_add_u32 v5, 143360, v5
    s_mov_b32 s59, 0
L_x_hs:
    ds_read_b32 v26, v5
    s_add_u32 s59, s59, 1
    s_cmp_ge_u32 s59, 200000
    s_cbranch_scc1 L_x_hsd
    s_waitcnt lgkmcnt(0)
    v_cmp_ne_u32 vcc, s42, v26
    s_cbranch_vccnz L_x_hs
L_x_hsd:
    s_waitcnt vmcnt(7)
    v_dot2c_f32_bf16 v48, s49, v32
    v_dot2c_f32_bf16 v49, v32, v32
    v_dot2c_f32_bf16 v48, s49, v33
    v_dot2c_f32_bf16 v49, v33, v33
    v_dot2c_f32_bf16 v48, s49, v34
    v_dot2c_f32_bf16 v49, v34, v34
    v_dot2c_f32_bf16 v48, s49, v35
    v_dot2c_f32_bf16 v49, v35, v35
    v_dot2c_f32_bf16 v48, s49, v36
    v_dot2c_f32_bf16 v49, v36, v36
    v_dot2c_f32_bf16 v48, s49, v37
    v_dot2c_f32_bf16 v49, v37, v37
    v_dot2c_f32_bf16 v48, s49, v38
    v_dot2c_f32_bf16 v49, v38, v38
    v_dot2c_f32_bf16 v48, s49, v39
    v_dot2c_f32_bf16 v49, v39, v39
    v_dot2c_f32_bf16 v48, s49, v40
    v_dot2c_f32_bf16 v49, v40, v40
    v_dot2c_f32_bf16 v48, s49, v41
    v_dot2c_f32_bf16 v49, v41, v41
    v_dot2c_f32_bf16 v48, s49, v42
    v_dot2c_f32_bf16 v49, v42, v42
    v_dot2c_f32_bf16 v48, s49, v43
    v_dot2c_f32_bf16 v49, v43, v43
    v_dot2c_f32_bf16 v48, s49, v44
    v_dot2c_f32_bf16 v49, v44, v44
    v_dot2c_f32_bf16 v48, s49, v45
    v_dot2c_f32_bf16 v49, v45, v45
    v_dot2c_f32_bf16 v48, s49, v46
    v_dot2c_f32_bf16 v49, v46, v46
    v_dot2c_f32_bf16 v48, s49, v47
    v_dot2c_f32_bf16 v49, v47, v47
    s_waitcnt vmcnt(2)
    v_dot2c_f32_bf16 v51, s49, v80
    v_dot2c_f32_bf16 v51, s49, v81
    v_add_f32_dpp v48, v48, v48 row_shr:1 row_mask:0xf bank_mask:0xf bound_ctrl:0
    v_add_f32_dpp v49, v49, v49 row_shr:1 row_mask:0xf bank_mask:0xf bound_ctrl:0
    v_dot2c_f32_bf16 v51, s49, v82
    v_add_f32_dpp v48, v48, v48 row_shr:2 row_mask:0xf bank_mask:0xf bound_ctrl:0
    v_add_f32_dpp v49, v49, v49 row_shr:2 row_mask:0xf bank_mask:0xf bound_ctrl:0
    v_dot2c_f32_bf16 v51, s49, v83
    v_add_f32_dpp v48, v48, v48 row_shr:4 row_mask:0xf bank_mask:0xf bound_ctrl:0
    v_add_f32_dpp v49, v49, v49 row_shr:4 row_mask:0xf bank_mask:0xf bound_ctrl:0
    v_dot2c_f32_bf16 v50, v32, v64
    v_add_f32_dpp v48, v48, v48 row_shr:8 row_mask:0xf bank_mask:0xf bound_ctrl:0
    v_add_f32_dpp v49, v49, v49 row_shr:8 row_mask:0xf bank_mask:0xf bound_ctrl:0
    v_mul_f32 v48, 0x3b124925, v48
    v_mul_f32 v49, 0x3b124925, v49
    v_fma_f32 v49, -v48, v48, v49
    v_max_f32 v49, 0, v49
    v_cvt_pk_bf16_f32 v52, v49, v48
    v_lshlrev_b32 v49, 16, v52
    v_add_f32 v49, 0x3727c5ac, v49
    v_cvt_pk_bf16_f32 v49, v49, v49
    v_lshlrev_b32 v49, 16, v49
    v_sqrt_f32 v49, v49
    v_and_b32 v59, 0xffff0000, v52
    v_cvt_pk_bf16_f32 v49, v49, v49
    v_lshlrev_b32 v49, 16, v49
    v_rcp_f32 v53, v49
    v_mov_b32_dpp v48, v59 row_bcast:15 row_mask:0xa bank_mask:0xf
    v_lshrrev_b32 v48, 16, v48
    v_or_b32 v54, v59, v48
    v_mov_b32_dpp v52, v53 row_bcast:15 row_mask:0xa bank_mask:0xf
    s_brev_b32 exec_lo, 1
    s_brev_b32 exec_hi, 1
    buffer_store_dwordx4 v[52:55], v100, s[36:39], s15 offen sc1
    s_mov_b64 exec, -1
    v_add_f32_dpp v51, v51, v51 row_shr:1 row_mask:0xf bank_mask:0xf bound_ctrl:0
    v_dot2c_f32_bf16 v50, v33, v65
    v_dot2c_f32_bf16 v50, v34, v66
    v_add_f32_dpp v51, v51, v51 row_shr:2 row_mask:0xf bank_mask:0xf bound_ctrl:0
    v_dot2c_f32_bf16 v50, v35, v67
    v_dot2c_f32_bf16 v50, v36, v68
    v_add_f32_dpp v51, v51, v51 row_shr:4 row_mask:0xf bank_mask:0xf bound_ctrl:0
    v_dot2c_f32_bf16 v50, v37, v69
    v_dot2c_f32_bf16 v50, v38, v70
    v_add_f32_dpp v51, v51, v51 row_shr:8 row_mask:0xf bank_mask:0xf bound_ctrl:0
    v_dot2c_f32_bf16 v50, v39, v71
    v_dot2c_f32_bf16 v50, v40, v72
    v_add_f32_dpp v51, v51, v51 row_bcast:15 row_mask:0xa bank_mask:0xf
    v_dot2c_f32_bf16 v50, v41, v73
    v_dot2c_f32_bf16 v50, v42, v74
    v_add_f32_dpp v51, v51, v51 row_bcast:31 row_mask:0xc bank_mask:0xf
    v_dot2c_f32_bf16 v50, v43, v75
    v_dot2c_f32_bf16 v50, v44, v76
    v_dot2c_f32_bf16 v50, v45, v77
    v_dot2c_f32_bf16 v50, v46, v78
    v_dot2c_f32_bf16 v50, v47, v79
    v_readlane_b32 s49, v51, 63
    s_nop 1
    v_add_f32_dpp v50, v50, v50 row_shr:1 row_mask:0xf bank_mask:0xf bound_ctrl:0
    s_nop 1
    v_add_f32_dpp v50, v50, v50 row_shr:2 row_mask:0xf bank_mask:0xf bound_ctrl:0
    s_nop 1
    v_add_f32_dpp v50, v50, v50 row_shr:4 row_mask:0xf bank_mask:0xf bound_ctrl:0
    s_nop 1
    v_add_f32_dpp v50, v50, v50 row_shr:8 row_mask:0xf bank_mask:0xf bound_ctrl:0
    v_fma_f32 v50, -v59, s49, v50
    v_mul_f32 v50, v50, v53
    v_cvt_pk_bf16_f32 v50, v50, v50
    v_ashrrev_i32 v51, 31, v50
    v_or_b32 v51, 0x80000000, v51
    v_xor_b32 v50, v50, v51
    v_and_or_b32 v56, v50, s50, v58
    s_nop 1
    v_max_u32_dpp v56, v56, v56 row_bcast:15 row_mask:0xa bank_mask:0xf
    s_nop 1
    v_max_u32_dpp v56, v56, v56 row_bcast:31 row_mask:0xc bank_mask:0xf
    s_mov_b32 exec_lo, 0
    s_brev_b32 exec_hi, 1
    buffer_store_dwordx2 v[56:57], off, s[36:39], s18 sc1
    s_mov_b64 exec, -1
    s_branch L_x_pub
L_x_tile1:
    v_mov_b32 v67, s42
    v_mov_b32 v71, s42
    v_mov_b32 v75, s42
    s_waitcnt vmcnt(0)
    buffer_store_dwordx4 v[64:67], v100, s[36:39], s15 offen sc1
    buffer_store_dwordx4 v[68:71], v100, s[36:39], s15 offen offset:128 sc1
    buffer_store_dwordx4 v[72:75], v100, s[36:39], s15 offen offset:256 sc1
L_x_pub:
    s_mov_b64 s[8:9], s[26:27]
    s_cmp_lg_u32 s40, 0
    s_cbranch_scc1 L_x_nopf
    s_mov_b32 s10, 1605632
    s_mov_b32 s11, 0x20000
    s_mov_b64 s[20:21], s[22:23]
    s_mov_b32 s22, 1605632
    s_mov_b32 s23, 0x20000
    s_mov_b32 s26, 1605632
    s_mov_b32 s27, 0x20000
    buffer_load_dword v105, v102, s[8:11], 0 offen
L_x_nopf:
    s_waitcnt lgkmcnt(0)
    s_load_dword s55, s[16:17], s48
    s_mov_b32 s49, 0
    s_barrier
    buffer_load_dwordx4 v[112:115], v11, s[36:39], s51 offen sc1
    buffer_load_dwordx4 v[116:119], v12, s[36:39], s51 offen offset:256 sc1
    buffer_load_dwordx4 v[120:123], v13, s[36:39], s52 offen sc1
    buffer_load_dwordx4 v[124:127], v13, s[36:39], s53 offen sc1
    s_barrier
    s_barrier
L_x_poll:
    s_waitcnt vmcnt(0)
L_x_poll1:
    v_xor_b32 v5, s42, v115
    v_bitop3_b32 v5, v119, s42, v5 bitop3:0xbe
    v_bitop3_b32 v5, v123, s42, v5 bitop3:0xbe
    v_bitop3_b32 v5, v127, s42, v5 bitop3:0xbe
    v_cmp_ne_u32 vcc, 0, v5
    s_cbranch_vccz L_x_polled
    s_add_u32 s49, s49, 1
    s_cmp_ge_u32 s49, 200000
    s_cbranch_scc1 L_x_polled
    s_mov_b64 exec, vcc
    buffer_load_dwordx4 v[112:115], v11, s[36:39], s51 offen sc1
    buffer_load_dwordx4 v[116:119], v12, s[36:39], s51 offen offset:256 sc1
    buffer_load_dwordx4 v[120:123], v13, s[36:39], s52 offen sc1
    buffer_load_dwordx4 v[124:127], v13, s[36:39], s53 offen sc1
    s_branch L_x_poll
L_x_polled:
    s_mov_b64 exec, -1
    v_cndmask_b32 v115, v116, v117, s[56:57]
    v_lshlrev_b32 v44, 16, v122
    v_and_b32 v45, 0xffff0000, v122
    v_lshlrev_b32 v46, 16, v126
    v_and_b32 v47, 0xffff0000, v126
    v_lshlrev_b32 v64, 16, v112
    v_and_b32 v65, 0xffff0000, v112
    v_lshlrev_b32 v66, 16, v113
    v_and_b32 v67, 0xffff0000, v113
    v_lshlrev_b32 v68, 16, v114
    v_and_b32 v69, 0xffff0000, v114
    v_lshlrev_b32 v70, 16, v115
    v_and_b32 v71, 0xffff0000, v115
    v_pk_add_f32 v[32:33], v[64:65], v[44:45] op_sel:[0,0] op_sel_hi:[1,0] neg_lo:[0,1] neg_hi:[0,1]
    v_pk_add_f32 v[34:35], v[66:67], v[44:45] op_sel:[0,1] op_sel_hi:[1,1] neg_lo:[0,1] neg_hi:[0,1]
    v_pk_add_f32 v[36:37], v[68:69], v[46:47] op_sel:[0,0] op_sel_hi:[1,0] neg_lo:[0,1] neg_hi:[0,1]
    v_pk_add_f32 v[38:39], v[70:71], v[46:47] op_sel:[0,1] op_sel_hi:[1,1] neg_lo:[0,1] neg_hi:[0,1]
    v_pk_mul_f32 v[32:33], v[32:33], v[120:121] op_sel:[0,0] op_sel_hi:[1,0]
    v_pk_mul_f32 v[34:35], v[34:35], v[120:121] op_sel:[0,1] op_sel_hi:[1,1]
    v_pk_mul_f32 v[36:37], v[36:37], v[124:125] op_sel:[0,0] op_sel_hi:[1,0]
    v_pk_mul_f32 v[38:39], v[38:39], v[124:125] op_sel:[0,1] op_sel_hi:[1,1]
    v_cvt_pk_bf16_f32 v40, v38, v36
    v_cvt_pk_bf16_f32 v41, v34, v32
    ds_write_b64 v7, v[40:41]
    v_cvt_pk_bf16_f32 v42, v39, v37
    v_cvt_pk_bf16_f32 v43, v35, v33
    ds_write_b64 v7, v[42:43] offset:4576
    s_waitcnt lgkmcnt(0)
    s_barrier
    s_lshl_b32 s49, s55, 16
    s_and_b32 s50, s55, 0xffff0000
    v_add_f32 v14, s49, 1.0
    v_add_f32 v15, s50, 1.0
    v_fma_f32 v16, v32, v14, v64
    v_fma_f32 v20, v33, v15, v65
    v_fma_f32 v17, v34, v14, v66
    v_fma_f32 v21, v35, v15, v67
    v_fma_f32 v18, v36, v14, v68
    v_fma_f32 v22, v37, v15, v69
    v_fma_f32 v19, v38, v14, v70
    v_fma_f32 v23, v39, v15, v71
    s_bitcmp1_b32 s60, 1
    s_cselect_b64 s[56:57], -1, 0
    s_movk_i32 s59, 2048
    v_mul_u32_u24 v13, 3584, v0
    s_barrier
    s_cmp_lt_u32 s40, 3
    s_cbranch_scc1 L_x_epi
    buffer_load_dwordx2 v[60:61], off, s[36:39], s59 sc1
    s_barrier
    s_cmp_lt_u32 s40, 5
    s_cbranch_scc1 L_x_epi
    s_barrier
    s_cmp_lt_u32 s40, 6
    s_cbranch_scc1 L_x_epi
    s_barrier
    s_cmp_lt_u32 s40, 7
    s_cbranch_scc1 L_x_epi
    s_waitcnt vmcnt(0)
    s_barrier
    v_readfirstlane_b32 s52, v60
    s_lshr_b32 s53, s52, 8
    s_cmp_lg_u32 s53, s40
    s_cbranch_scc1 L_x_epi
    s_mov_b64 exec, 0xfffffff
    buffer_load_dwordx4 v[92:95], v8, s[36:39], s54 offen sc1
    s_mov_b64 exec, -1
L_x_epi:
    ds_read_b64 v[32:33], v24 offset:0
    ds_read_b64 v[34:35], v24 offset:576
    ds_read_b64 v[36:37], v24 offset:2304
    ds_read_b64 v[38:39], v24 offset:2880
    ds_read_b64 v[40:41], v24 offset:1152
    ds_read_b64 v[42:43], v24 offset:1728
    ds_read_b64 v[44:45], v24 offset:3456
    ds_read_b64 v[46:47], v24 offset:4032
    s_waitcnt lgkmcnt(6)
    v_mfma_f32_16x16x32_bf16 v[16:19], v[28:31], v[32:35], v[16:19]
    s_waitcnt lgkmcnt(4)
    v_mfma_f32_16x16x32_bf16 v[20:23], v[28:31], v[36:39], v[20:23]
    s_waitcnt lgkmcnt(2)
    v_mfma_f32_16x16x32_bf16 v[16:19], v[28:31], v[40:43], v[16:19]
    s_waitcnt lgkmcnt(0)
    v_mfma_f32_16x16x32_bf16 v[20:23], v[28:31], v[44:47], v[20:23]
    s_mov_b32 s49, 0
    s_cmp_lt_u32 s40, 5
    s_nop 5
    v_cvt_pk_bf16_f32 v84, v16, v20
    v_cvt_pk_bf16_f32 v88, v19, v23
    v_cvt_pk_bf16_f32 v85, v17, v21
    v_cvt_pk_bf16_f32 v86, v18, v22
    s_cbranch_scc1 L_x_tpub
    buffer_store_dword v84, v13, s[28:31], s48 offen
    buffer_store_dword v85, v13, s[28:31], s48 offen offset:896
    buffer_store_dword v86, v13, s[28:31], s48 offen offset:1792
    buffer_store_dword v88, v13, s[28:31], s48 offen offset:2688
    s_waitcnt vmcnt(4)
    s_cmp_ge_u32 s40, 7
    s_cbranch_scc1 L_x_ichk
    s_barrier
    s_cmp_ge_u32 s40, 6
    s_cbranch_scc1 L_x_ichk
    s_barrier
    s_cmp_ge_u32 s40, 5
    s_cbranch_scc1 L_x_ichk
    s_barrier
L_x_ichk:
    v_cmp_ne_u32 vcc, s42, v61
    s_cbranch_vccz L_x_fin
    s_add_u32 s49, s49, 1
    s_cmp_ge_u32 s49, 200000
    s_cbranch_scc1 L_x_fin
    buffer_load_dwordx2 v[60:61], off, s[36:39], s59 sc1
    s_waitcnt vmcnt(0)
    s_branch L_x_ichk
L_x_tpub:
    v_mov_b32_dpp v89, v88 row_ror:8 row_mask:0xf bank_mask:0xf
    buffer_store_dwordx4 v[84:87], v11, s[36:39], s51 offen sc1
    s_mov_b32 exec_lo, 0x00ff00ff
    s_mov_b32 exec_hi, 0x00ff00ff
    buffer_store_dwordx4 v[88:91], v11, s[36:39], s51 offen offset:256 sc1
    s_mov_b64 exec, -1
    buffer_load_dwordx2 v[60:61], off, s[36:39], s59 sc1
    s_cmp_ge_u32 s40, 3
    s_cbranch_scc1 L_x_t1
    s_barrier
    s_barrier
    buffer_load_dwordx4 v[112:115], v6, s[36:39], s63 offen sc1
    buffer_load_dwordx4 v[116:119], v6, s[36:39], s32 offen offset:256 sc1
    s_barrier
    s_barrier
    s_waitcnt vmcnt(0)
    v_readfirstlane_b32 s52, v60
    s_lshr_b32 s53, s52, 8
    s_cmp_lg_u32 s53, s40
    s_cbranch_scc1 L_x_y1
    s_mov_b64 exec, 0xfffffff
    buffer_load_dwordx4 v[92:95], v8, s[36:39], s54 offen sc1
    s_mov_b64 exec, -1
L_x_y1:
    s_branch L_x_y2
L_x_t1:
    s_barrier
    s_barrier
    s_barrier
    buffer_load_dwordx4 v[112:115], v6, s[36:39], s63 offen sc1
    buffer_load_dwordx4 v[116:119], v6, s[36:39], s32 offen offset:256 sc1
    s_waitcnt vmcnt(2)
    v_readfirstlane_b32 s52, v60
    s_lshr_b32 s53, s52, 8
    s_cmp_lg_u32 s53, s40
    s_cbranch_scc1 L_x_ypoll
    s_mov_b64 exec, 0xfffffff
    buffer_load_dwordx4 v[92:95], v8, s[36:39], s54 offen sc1
    s_mov_b64 exec, -1
L_x_ypoll:
    s_waitcnt vmcnt(0)
L_x_y2:
    v_xor_b32 v5, s58, v115
    v_bitop3_b32 v5, v119, s58, v5 bitop3:0xbe
    v_bitop3_b32 v5, v61, s42, v5 bitop3:0xbe
    v_cmp_ne_u32 vcc, 0, v5
    s_cbranch_vccz L_x_ypolled
    s_add_u32 s49, s49, 1
    s_cmp_ge_u32 s49, 200000
    s_cbranch_scc1 L_x_ypolled
    s_mov_b64 exec, vcc
    buffer_load_dwordx2 v[60:61], off, s[36:39], s59 sc1
    buffer_load_dwordx4 v[112:115], v6, s[36:39], s63 offen sc1
    buffer_load_dwordx4 v[116:119], v6, s[36:39], s32 offen offset:256 sc1
    s_branch L_x_ypoll
L_x_ypolled:
    s_mov_b64 exec, -1
    v_cndmask_b32 v115, v116, v117, s[56:57]
    v_sub_u32 v4, v60, v4
    ds_write_b128 v9, v[112:115]
    ds_read_b128 v[116:119], v10
    v_cmp_ne_u32 s[12:13], 0, v4
    v_cmp_ne_u32 s[14:15], 1, v4
    v_cmp_ne_u32 s[16:17], 2, v4
    v_cmp_ne_u32 s[18:19], 3, v4
    s_waitcnt lgkmcnt(0)
    s_mov_b64 exec, s[12:13]
    buffer_store_dword v116, v3, s[28:31], s33 offen offset:0
    s_mov_b64 exec, s[14:15]
    buffer_store_dword v117, v3, s[28:31], s33 offen offset:896
    s_mov_b64 exec, s[16:17]
    buffer_store_dword v118, v3, s[28:31], s33 offen offset:1792
    s_mov_b64 exec, s[18:19]
    buffer_store_dword v119, v3, s[28:31], s33 offen offset:2688
    s_mov_b64 exec, -1
    s_waitcnt vmcnt(4)
L_x_fin:
    v_readfirstlane_b32 s52, v60
    s_lshr_b32 s53, s52, 8
    s_cmp_lg_u32 s53, s40
    s_cbranch_scc1 L_x_end
    s_mov_b64 exec, 0xfffffff
    s_mov_b32 s49, 0
L_x_fpoll:
    v_cmp_ne_u32 vcc, s42, v95
    s_cbranch_vccz L_x_fpolled
    s_add_u32 s49, s49, 1
    s_cmp_ge_u32 s49, 200000
    s_cbranch_scc1 L_x_fpolled
    s_mov_b64 exec, vcc
    buffer_load_dwordx4 v[92:95], v8, s[36:39], s54 offen sc1
    s_waitcnt vmcnt(0)
    s_branch L_x_fpoll
L_x_fpolled:
    s_mov_b64 exec, -1
    s_bitcmp1_b32 s52, 0
    s_cselect_b64 s[12:13], -1, 0
    s_bitcmp1_b32 s52, 1
    s_cselect_b64 s[14:15], -1, 0
    v_add_f32_dpp v92, v92, v92 row_shr:1 row_mask:0xf bank_mask:0xf bound_ctrl:0
    v_add_f32_dpp v93, v93, v93 row_shr:1 row_mask:0xf bank_mask:0xf bound_ctrl:0
    v_cndmask_b32 v16, v16, v17, s[12:13]
    v_add_f32_dpp v92, v92, v92 row_shr:2 row_mask:0xf bank_mask:0xf bound_ctrl:0
    v_add_f32_dpp v93, v93, v93 row_shr:2 row_mask:0xf bank_mask:0xf bound_ctrl:0
    v_cndmask_b32 v18, v18, v19, s[12:13]
    v_add_f32_dpp v92, v92, v92 row_shr:4 row_mask:0xf bank_mask:0xf bound_ctrl:0
    v_add_f32_dpp v93, v93, v93 row_shr:4 row_mask:0xf bank_mask:0xf bound_ctrl:0
    v_cndmask_b32 v20, v20, v21, s[12:13]
    v_add_f32_dpp v92, v92, v92 row_shr:8 row_mask:0xf bank_mask:0xf bound_ctrl:0
    v_add_f32_dpp v93, v93, v93 row_shr:8 row_mask:0xf bank_mask:0xf bound_ctrl:0
    v_cndmask_b32 v22, v22, v23, s[12:13]
    v_add_f32_dpp v92, v92, v92 row_bcast:15 row_mask:0xa bank_mask:0xf
    v_add_f32_dpp v93, v93, v93 row_bcast:15 row_mask:0xa bank_mask:0xf
    v_cndmask_b32 v16, v16, v18, s[14:15]
    v_cndmask_b32 v17, v20, v22, s[14:15]
    s_bfe_u32 s49, s52, 0x60002
    s_lshl_b64 exec, 1, s49
    v_readlane_b32 s12, v92, 31
    v_readlane_b32 s13, v93, 31
    s_mul_i32 s49, s52, 896
    s_add_u32 s49, s49, s48
    v_add_f32 v16, s12, v16
    v_add_f32 v17, s13, v17
    v_cvt_pk_bf16_f32 v16, v16, v17
    buffer_store_dword v16, off, s[28:31], s49
    s_cmp_lg_u32 s41, 0
    s_cbranch_scc1 L_x_end
    v_mov_b32 v5, s42
    buffer_store_dword v5, off, s[36:39], 0
L_x_end:
    s_endpgm
L_kw:
    s_sub_u32 s45, s40, 8
    s_lshr_b32 s46, s45, 2
    v_lshrrev_b32 v5, 5, v1
    v_and_b32 v3, 31, v1
    s_mul_i32 s49, s45, 5984
    s_mov_b32 m0, s49
    v_mul_u32_u24 v30, 272, v3
    v_lshl_add_u32 v30, v5, 4, v30
    v_add_u32 v28, s49, v30
    s_mul_i32 s53, s45, 8704
    v_add_u32 v30, s53, v30
    s_lshl_b32 s49, s45, 5
    v_add_u32 v7, s49, v3
    v_mul_u32_u24 v20, 34816, v5
    v_lshl_add_u32 v20, v7, 2, v20
    v_add_u32 v20, 47872, v20
    v_mul_u32_u24 v29, 8320, v5
    v_lshl_add_u32 v29, v7, 4, v29
    v_add_u32 v29, 126752, v29
    v_and_b32 v8, 15, v1
    v_lshrrev_b32 v9, 4, v1
    s_and_b32 s50, s45, 3
    s_lshl_b32 s52, s50, 7
    s_mul_i32 s51, s46, 8320
    s_add_u32 s51, s51, s52
    s_add_u32 s51, s51, 130884
    v_and_b32 v10, 1, v8
    v_mul_u32_u24 v10, 4160, v10
    v_sub_u32 v10, s51, v10
    v_lshrrev_b32 v11, 1, v8
    v_lshl_add_u32 v10, v11, 2, v10
    v_lshl_add_u32 v0, v9, 4, v10
    s_mul_i32 s51, s46, 4576
    s_add_u32 s51, s51, s52
    s_add_u32 s51, s51, 117984
    v_lshlrev_b32 v10, 5, v8
    v_sub_u32 v10, s51, v10
    v_lshl_add_u32 v2, v9, 4, v10
    s_mul_i32 s51, s45, 576
    v_lshl_add_u32 v10, v5, 6, s51
    v_lshl_add_u32 v31, v1, 3, v10
    s_lshl_b32 s49, s46, 4
    s_sub_u32 s49, 16, s49
    v_mov_b32 v4, 1069066811
    s_waitcnt lgkmcnt(0)
    s_lshl_b32 s54, s54, s49
    s_and_b32 s54, s54, 0xffff0000
    v_mul_f32 v4, s54, v4
    v_exp_f32 v4, v4
    s_setprio 1
    s_waitcnt vmcnt(0)
    v_mul_f32 v16, 1069066811, v16
    v_exp_f32 v16, v16
    v_mov_b32 v8, 0x3f80
    v_cvt_pk_bf16_f32 v4, v4, v16
    ds_write_addtid_b32 v8 offset:0
    v_and_b32 v16, 0xffff0000, v4
    v_lshlrev_b32 v4, 16, v4
    v_mul_f32 v16, v16, v4
    v_mul_f32 v17, v17, v4
    v_add_f32 v4, v4, v4
    v_mul_f32 v16, 0xbfb8aa3b, v16
    v_mul_f32 v17, 0.15915494, v17
    v_mul_f32 v18, v18, v4
    v_mul_f32 v19, -v19, v4
    v_fract_f32 v7, v17
    v_mul_f32 v9, 0x43800000, v17
    v_exp_f32 v6, v16
    v_mul_f32 v8, 0x43800000, v16
    v_fract_f32 v9, v9
    v_cos_f32 v32, v7
    v_sin_f32 v33, v7
    v_exp_f32 v8, v8
    v_cos_f32 v36, v9
    v_sin_f32 v37, v9
    v_pk_mul_f32 v[32:33], v[32:33], v[6:7] op_sel_hi:[1,0]
    v_pk_mul_f32 v[36:37], v[36:37], v[8:9] op_sel_hi:[1,0]
    s_setprio 0
.p2align 3
    v_cvt_pk_bf16_f32 v8, v32, v33
    v_pk_mul_f32 v[38:39], v[32:33], v[32:33] op_sel_hi:[0,1]
    v_pk_fma_f32 v[38:39], v[32:33], v[32:33], v[38:39] op_sel:[1,1,0] op_sel_hi:[1,0,1] neg_lo:[0,1,0]
    ds_write_addtid_b32 v8 offset:3264
    v_cvt_pk_bf16_f32 v9, v36, v37
    v_pk_mul_f32 v[40:41], v[36:37], v[36:37] op_sel_hi:[0,1]
    v_pk_fma_f32 v[40:41], v[36:37], v[36:37], v[40:41] op_sel:[1,1,0] op_sel_hi:[1,0,1] neg_lo:[0,1,0]
    ds_write_addtid_b32 v9 offset:1088
    v_cvt_pk_bf16_f32 v10, v38, v39
    v_pk_mul_f32 v[42:43], v[38:39], v[32:33] op_sel_hi:[0,1]
    v_pk_fma_f32 v[42:43], v[38:39], v[32:33], v[42:43] op_sel:[1,1,0] op_sel_hi:[1,0,1] neg_lo:[0,1,0]
    ds_write_addtid_b32 v10 offset:2992
    v_cvt_pk_bf16_f32 v11, v40, v41
    v_pk_mul_f32 v[44:45], v[40:41], v[36:37] op_sel_hi:[0,1]
    v_pk_fma_f32 v[44:45], v[40:41], v[36:37], v[44:45] op_sel:[1,1,0] op_sel_hi:[1,0,1] neg_lo:[0,1,0]
    ds_write_addtid_b32 v11 offset:272
    v_cvt_pk_bf16_f32 v8, v42, v43
    v_pk_mul_f32 v[46:47], v[38:39], v[38:39] op_sel_hi:[0,1]
    v_pk_fma_f32 v[46:47], v[38:39], v[38:39], v[46:47] op_sel:[1,1,0] op_sel_hi:[1,0,1] neg_lo:[0,1,0]
    ds_write_addtid_b32 v8 offset:4624
    v_cvt_pk_bf16_f32 v9, v44, v45
    v_pk_mul_f32 v[48:49], v[40:41], v[40:41] op_sel_hi:[0,1]
    v_pk_fma_f32 v[48:49], v[40:41], v[40:41], v[48:49] op_sel:[1,1,0] op_sel_hi:[1,0,1] neg_lo:[0,1,0]
    ds_write_addtid_b32 v9 offset:1360
    v_cvt_pk_bf16_f32 v10, v46, v47
    v_pk_mul_f32 v[50:51], v[46:47], v[38:39] op_sel_hi:[0,1]
    v_pk_fma_f32 v[50:51], v[46:47], v[38:39], v[50:51] op_sel:[1,1,0] op_sel_hi:[1,0,1] neg_lo:[0,1,0]
    ds_write_addtid_b32 v10 offset:2448
    v_cvt_pk_bf16_f32 v11, v48, v49
    v_pk_mul_f32 v[62:63], v[46:47], v[32:33] op_sel_hi:[0,1]
    v_pk_fma_f32 v[62:63], v[46:47], v[32:33], v[62:63] op_sel:[1,1,0] op_sel_hi:[1,0,1] neg_lo:[0,1,0]
    ds_write_addtid_b32 v11 offset:544
    v_cvt_pk_bf16_f32 v8, v50, v51
    v_pk_mul_f32 v[56:57], v[46:47], v[42:43] op_sel_hi:[0,1]
    v_pk_fma_f32 v[56:57], v[46:47], v[42:43], v[56:57] op_sel:[1,1,0] op_sel_hi:[1,0,1] neg_lo:[0,1,0]
    ds_write_addtid_b32 v8 offset:4352
    v_cvt_pk_bf16_f32 v9, v62, v63
    v_pk_mul_f32 v[58:59], v[36:37], v[38:39] op_sel_hi:[0,1]
    v_pk_fma_f32 v[58:59], v[36:37], v[38:39], v[58:59] op_sel:[1,1,0] op_sel_hi:[1,0,1] neg_lo:[0,1,0]
    ds_write_addtid_b32 v9 offset:5712
    v_cvt_pk_bf16_f32 v10, v56, v57
    v_pk_mul_f32 v[60:61], v[36:37], v[46:47] op_sel_hi:[0,1]
    v_pk_fma_f32 v[60:61], v[36:37], v[46:47], v[60:61] op_sel:[1,1,0] op_sel_hi:[1,0,1] neg_lo:[0,1,0]
    ds_write_addtid_b32 v10 offset:4896
    v_cvt_pk_bf16_f32 v11, v58, v59
    v_pk_mul_f32 v[62:63], v[36:37], v[50:51] op_sel_hi:[0,1]
    v_pk_fma_f32 v[62:63], v[36:37], v[50:51], v[62:63] op_sel:[1,1,0] op_sel_hi:[1,0,1] neg_lo:[0,1,0]
    ds_write_addtid_b32 v11 offset:4080
    v_cvt_pk_bf16_f32 v8, v60, v61
    v_pk_mul_f32 v[56:57], v[40:41], v[46:47] op_sel_hi:[0,1]
    v_pk_fma_f32 v[56:57], v[40:41], v[46:47], v[56:57] op_sel:[1,1,0] op_sel_hi:[1,0,1] neg_lo:[0,1,0]
    ds_write_addtid_b32 v8 offset:3536
    v_cvt_pk_bf16_f32 v9, v62, v63
    v_pk_mul_f32 v[58:59], v[44:45], v[46:47] op_sel_hi:[0,1]
    v_pk_fma_f32 v[58:59], v[44:45], v[46:47], v[58:59] op_sel:[1,1,0] op_sel_hi:[1,0,1] neg_lo:[0,1,0]
    ds_write_addtid_b32 v9 offset:5440
    v_cvt_pk_bf16_f32 v10, v56, v57
    v_pk_mul_f32 v[60:61], v[48:49], v[36:37] op_sel_hi:[0,1]
    v_pk_fma_f32 v[60:61], v[48:49], v[36:37], v[60:61] op_sel:[1,1,0] op_sel_hi:[1,0,1] neg_lo:[0,1,0]
    ds_write_addtid_b32 v10 offset:2720
    v_cvt_pk_bf16_f32 v11, v58, v59
    v_pk_mul_f32 v[62:63], v[48:49], v[40:41] op_sel_hi:[0,1]
    v_pk_fma_f32 v[62:63], v[48:49], v[40:41], v[62:63] op_sel:[1,1,0] op_sel_hi:[1,0,1] neg_lo:[0,1,0]
    ds_write_addtid_b32 v11 offset:3808
    v_cvt_pk_bf16_f32 v8, v60, v61
    v_pk_mul_f32 v[56:57], v[48:49], v[44:45] op_sel_hi:[0,1]
    v_pk_fma_f32 v[56:57], v[48:49], v[44:45], v[56:57] op_sel:[1,1,0] op_sel_hi:[1,0,1] neg_lo:[0,1,0]
    ds_write_addtid_b32 v8 offset:1632
    v_cvt_pk_bf16_f32 v9, v62, v63
    v_pk_mul_f32 v[58:59], v[48:49], v[48:49] op_sel_hi:[0,1]
    v_pk_fma_f32 v[58:59], v[48:49], v[48:49], v[58:59] op_sel:[1,1,0] op_sel_hi:[1,0,1] neg_lo:[0,1,0]
    ds_write_addtid_b32 v9 offset:816
    v_cvt_pk_bf16_f32 v10, v56, v57
    v_pk_mul_f32 v[14:15], v[46:47], v[46:47] op_sel_hi:[0,1] neg_hi:[0,1]
    v_pk_fma_f32 v[14:15], v[46:47], v[46:47], v[14:15] op_sel:[1,1,0] op_sel_hi:[1,0,1] neg_lo:[0,1,0] neg_hi:[0,1,0]
    ds_write_addtid_b32 v10 offset:1904
    v_cvt_pk_bf16_f32 v11, v58, v59
    ds_write_addtid_b32 v11 offset:2176
    s_mov_b32 m0, s53
    s_mov_b32 s49, 2
.p2align 3
L_k_bchain:
    v_cvt_pk_bf16_f32 v8, v18, v19
    v_pk_mul_f32 v[12:13], v[18:19], v[14:15] op_sel_hi:[0,1]
    v_pk_fma_f32 v[18:19], v[18:19], v[14:15], v[12:13] op_sel:[1,1,0] op_sel_hi:[1,0,1] neg_lo:[0,1,0]
    ds_write_addtid_b32 v8 offset:47872
    v_cvt_pk_bf16_f32 v9, v18, v19
    v_pk_mul_f32 v[12:13], v[18:19], v[14:15] op_sel_hi:[0,1]
    v_pk_fma_f32 v[18:19], v[18:19], v[14:15], v[12:13] op_sel:[1,1,0] op_sel_hi:[1,0,1] neg_lo:[0,1,0]
    ds_write_addtid_b32 v9 offset:48144
    v_cvt_pk_bf16_f32 v10, v18, v19
    v_pk_mul_f32 v[12:13], v[18:19], v[14:15] op_sel_hi:[0,1]
    v_pk_fma_f32 v[18:19], v[18:19], v[14:15], v[12:13] op_sel:[1,1,0] op_sel_hi:[1,0,1] neg_lo:[0,1,0]
    ds_write_addtid_b32 v10 offset:48416
    v_cvt_pk_bf16_f32 v11, v18, v19
    v_pk_mul_f32 v[12:13], v[18:19], v[14:15] op_sel_hi:[0,1]
    v_pk_fma_f32 v[18:19], v[18:19], v[14:15], v[12:13] op_sel:[1,1,0] op_sel_hi:[1,0,1] neg_lo:[0,1,0]
    ds_write_addtid_b32 v11 offset:48688
    v_cvt_pk_bf16_f32 v8, v18, v19
    v_pk_mul_f32 v[12:13], v[18:19], v[14:15] op_sel_hi:[0,1]
    v_pk_fma_f32 v[18:19], v[18:19], v[14:15], v[12:13] op_sel:[1,1,0] op_sel_hi:[1,0,1] neg_lo:[0,1,0]
    ds_write_addtid_b32 v8 offset:48960
    v_cvt_pk_bf16_f32 v9, v18, v19
    v_pk_mul_f32 v[12:13], v[18:19], v[14:15] op_sel_hi:[0,1]
    v_pk_fma_f32 v[18:19], v[18:19], v[14:15], v[12:13] op_sel:[1,1,0] op_sel_hi:[1,0,1] neg_lo:[0,1,0]
    ds_write_addtid_b32 v9 offset:49232
    v_cvt_pk_bf16_f32 v10, v18, v19
    v_pk_mul_f32 v[12:13], v[18:19], v[14:15] op_sel_hi:[0,1]
    v_pk_fma_f32 v[18:19], v[18:19], v[14:15], v[12:13] op_sel:[1,1,0] op_sel_hi:[1,0,1] neg_lo:[0,1,0]
    ds_write_addtid_b32 v10 offset:49504
    v_cvt_pk_bf16_f32 v11, v18, v19
    v_pk_mul_f32 v[12:13], v[18:19], v[14:15] op_sel_hi:[0,1]
    v_pk_fma_f32 v[18:19], v[18:19], v[14:15], v[12:13] op_sel:[1,1,0] op_sel_hi:[1,0,1] neg_lo:[0,1,0]
    ds_write_addtid_b32 v11 offset:49776
    v_cvt_pk_bf16_f32 v8, v18, v19
    v_pk_mul_f32 v[12:13], v[18:19], v[14:15] op_sel_hi:[0,1]
    v_pk_fma_f32 v[18:19], v[18:19], v[14:15], v[12:13] op_sel:[1,1,0] op_sel_hi:[1,0,1] neg_lo:[0,1,0]
    ds_write_addtid_b32 v8 offset:50048
    v_cvt_pk_bf16_f32 v9, v18, v19
    v_pk_mul_f32 v[12:13], v[18:19], v[14:15] op_sel_hi:[0,1]
    v_pk_fma_f32 v[18:19], v[18:19], v[14:15], v[12:13] op_sel:[1,1,0] op_sel_hi:[1,0,1] neg_lo:[0,1,0]
    ds_write_addtid_b32 v9 offset:50320
    v_cvt_pk_bf16_f32 v10, v18, v19
    v_pk_mul_f32 v[12:13], v[18:19], v[14:15] op_sel_hi:[0,1]
    v_pk_fma_f32 v[18:19], v[18:19], v[14:15], v[12:13] op_sel:[1,1,0] op_sel_hi:[1,0,1] neg_lo:[0,1,0]
    ds_write_addtid_b32 v10 offset:50592
    v_cvt_pk_bf16_f32 v11, v18, v19
    v_pk_mul_f32 v[12:13], v[18:19], v[14:15] op_sel_hi:[0,1]
    v_pk_fma_f32 v[18:19], v[18:19], v[14:15], v[12:13] op_sel:[1,1,0] op_sel_hi:[1,0,1] neg_lo:[0,1,0]
    ds_write_addtid_b32 v11 offset:50864
    v_cvt_pk_bf16_f32 v8, v18, v19
    v_pk_mul_f32 v[12:13], v[18:19], v[14:15] op_sel_hi:[0,1]
    v_pk_fma_f32 v[18:19], v[18:19], v[14:15], v[12:13] op_sel:[1,1,0] op_sel_hi:[1,0,1] neg_lo:[0,1,0]
    ds_write_addtid_b32 v8 offset:51136
    v_cvt_pk_bf16_f32 v9, v18, v19
    v_pk_mul_f32 v[12:13], v[18:19], v[14:15] op_sel_hi:[0,1]
    v_pk_fma_f32 v[18:19], v[18:19], v[14:15], v[12:13] op_sel:[1,1,0] op_sel_hi:[1,0,1] neg_lo:[0,1,0]
    ds_write_addtid_b32 v9 offset:51408
    v_cvt_pk_bf16_f32 v10, v18, v19
    v_pk_mul_f32 v[12:13], v[18:19], v[14:15] op_sel_hi:[0,1]
    v_pk_fma_f32 v[18:19], v[18:19], v[14:15], v[12:13] op_sel:[1,1,0] op_sel_hi:[1,0,1] neg_lo:[0,1,0]
    ds_write_addtid_b32 v10 offset:51680
    v_cvt_pk_bf16_f32 v11, v18, v19
    v_pk_mul_f32 v[12:13], v[18:19], v[14:15] op_sel_hi:[0,1]
    v_pk_fma_f32 v[18:19], v[18:19], v[14:15], v[12:13] op_sel:[1,1,0] op_sel_hi:[1,0,1] neg_lo:[0,1,0]
    ds_write_addtid_b32 v11 offset:51952
    s_add_u32 m0, m0, 4352
    s_sub_u32 s49, s49, 1
    s_cmp_lg_u32 s49, 0
    s_cbranch_scc1 L_k_bchain
    s_mov_b32 m0, s53
    ds_read_b128 v[64:67], v28 offset:0
    ds_read_b128 v[32:35], v30 offset:47872
    ds_read_b128 v[68:71], v28 offset:32
    ds_read_b128 v[36:39], v30 offset:47904
    ds_read_b128 v[72:75], v28 offset:64
    ds_read_b128 v[40:43], v30 offset:47936
    ds_read_b128 v[76:79], v28 offset:96
    ds_read_b128 v[44:47], v30 offset:47968
    v_add_u32 v21, 4, v20
    v_add_u32 v22, 128, v20
    v_cmp_eq_u32 vcc, 0, v3
    v_add_u32 v23, 2556, v20
    v_and_b32 v24, 1, v3
    v_cndmask_b32 v23, v20, v23, vcc
    v_cmp_eq_u32 s[56:57], 1, v24
    s_waitcnt lgkmcnt(6)
    v_mfma_f32_32x32x16_bf16 v[96:111], v[64:67], v[32:35], 0
    ds_read_b128 v[80:83], v28 offset:128
    ds_read_b128 v[48:51], v30 offset:48000
    s_waitcnt lgkmcnt(6)
    v_mfma_f32_32x32x16_bf16 v[96:111], v[68:71], v[36:39], v[96:111]
    ds_read_b128 v[84:87], v28 offset:160
    ds_read_b128 v[52:55], v30 offset:48032
    s_waitcnt lgkmcnt(6)
    v_mfma_f32_32x32x16_bf16 v[96:111], v[72:75], v[40:43], v[96:111]
    ds_read_b128 v[88:91], v28 offset:192
    ds_read_b128 v[56:59], v30 offset:48064
    s_waitcnt lgkmcnt(6)
    v_mfma_f32_32x32x16_bf16 v[96:111], v[76:79], v[44:47], v[96:111]
    ds_read_b128 v[92:95], v28 offset:224
    ds_read_b128 v[60:63], v30 offset:48096
    s_barrier
    s_waitcnt lgkmcnt(6)
    v_mfma_f32_32x32x16_bf16 v[96:111], v[80:83], v[48:51], v[96:111]
    s_waitcnt lgkmcnt(4)
    v_mfma_f32_32x32x16_bf16 v[96:111], v[84:87], v[52:55], v[96:111]
    s_waitcnt lgkmcnt(2)
    v_mfma_f32_32x32x16_bf16 v[96:111], v[88:91], v[56:59], v[96:111]
    s_waitcnt lgkmcnt(0)
    v_mfma_f32_32x32x16_bf16 v[96:111], v[92:95], v[60:63], v[96:111]
    v_add_u32 v3, 1024, v0
    v_add_u32 v4, 2048, v0
    v_add_u32 v5, 3072, v0
    v_mov_b32 v6, v31
    s_nop 7
    ds_write_addtid_b32 v96 offset:47872
    ds_write_addtid_b32 v97 offset:48128
    ds_write_addtid_b32 v98 offset:48384
    ds_write_addtid_b32 v99 offset:48640
    ds_write_addtid_b32 v100 offset:48896
    ds_write_addtid_b32 v101 offset:49152
    ds_write_addtid_b32 v102 offset:49408
    ds_write_addtid_b32 v103 offset:49664
    ds_write_addtid_b32 v104 offset:49920
    ds_write_addtid_b32 v105 offset:50176
    ds_write_addtid_b32 v106 offset:50432
    s_cmp_gt_u32 s45, 1
    s_waitcnt lgkmcnt(0)
    s_barrier
    s_cbranch_scc1 L_k_e23
    s_cmp_eq_u32 s45, 1
    s_cbranch_scc1 L_k_e1
    ds_read2st64_b32 v[32:33], v20 offset0:10 offset1:44
    ds_read2st64_b32 v[34:35], v20 offset0:78 offset1:112
    ds_read2st64_b32 v[36:37], v20 offset0:0 offset1:34
    ds_read2st64_b32 v[38:39], v20 offset0:68 offset1:102
    ds_read2st64_b32 v[40:41], v22 offset0:4 offset1:38
    ds_read2st64_b32 v[42:43], v22 offset0:72 offset1:106
    ds_read2st64_b32 v[44:45], v20 offset0:7 offset1:41
    ds_read2st64_b32 v[46:47], v20 offset0:75 offset1:109
    ds_read2st64_b32 v[48:49], v20 offset0:9 offset1:43
    ds_read2st64_b32 v[50:51], v20 offset0:77 offset1:111
    ds_read2st64_b32 v[52:53], v20 offset0:5 offset1:39
    ds_read2st64_b32 v[54:55], v20 offset0:73 offset1:107
    ds_read2st64_b32 v[56:57], v22 offset0:9 offset1:43
    ds_read2st64_b32 v[58:59], v22 offset0:77 offset1:111
    ds_read2st64_b32 v[60:61], v20 offset0:8 offset1:42
    ds_read2st64_b32 v[62:63], v20 offset0:76 offset1:110
    s_waitcnt lgkmcnt(14)
    v_pk_add_f32 v[32:33], v[32:33], v[34:35]
    v_add_f32 v32, v32, v33
    s_waitcnt lgkmcnt(12)
    v_pk_add_f32 v[36:37], v[36:37], v[38:39]
    v_add_f32 v36, v36, v37
    s_waitcnt lgkmcnt(10)
    v_pk_add_f32 v[40:41], v[40:41], v[42:43]
    v_add_f32 v40, v40, v41
    s_waitcnt lgkmcnt(8)
    v_pk_add_f32 v[44:45], v[44:45], v[46:47]
    v_add_f32 v44, v44, v45
    s_waitcnt lgkmcnt(6)
    v_pk_add_f32 v[48:49], v[48:49], v[50:51]
    v_add_f32 v48, v48, v49
    s_waitcnt lgkmcnt(4)
    v_pk_add_f32 v[52:53], v[52:53], v[54:55]
    v_add_f32 v52, v52, v53
    s_waitcnt lgkmcnt(2)
    v_pk_add_f32 v[56:57], v[56:57], v[58:59]
    v_add_f32 v56, v56, v57
    s_waitcnt lgkmcnt(0)
    v_pk_add_f32 v[60:61], v[60:61], v[62:63]
    v_add_f32 v60, v60, v61
    v_mov_b32_dpp v64, v32 wave_shr:1 row_mask:0xf bank_mask:0xf bound_ctrl:0
    v_writelane_b32 v64, 0, 32
    v_cvt_pk_bf16_f32 v68, v36, v40
    v_cvt_pk_bf16_f32 v69, v44, v48
    v_cvt_pk_bf16_f32 v70, v52, v56
    v_cvt_pk_bf16_f32 v71, v60, v32
    ds_write_b128 v29, v[68:71]
    v_cvt_pk_bf16_f32 v73, v40, v44
    v_cvt_pk_bf16_f32 v74, v48, v52
    v_cvt_pk_bf16_f32 v75, v56, v60
    v_cvt_pk_bf16_f32 v72, v64, v36
    s_branch L_k_ej
L_k_e1:
    ds_read2st64_b32 v[32:33], v20 offset0:0 offset1:34
    ds_read2st64_b32 v[34:35], v20 offset0:68 offset1:102
    ds_read2st64_b32 v[36:37], v20 offset0:7 offset1:41
    ds_read2st64_b32 v[38:39], v20 offset0:75 offset1:109
    ds_read2st64_b32 v[40:41], v20 offset0:5 offset1:39
    ds_read2st64_b32 v[42:43], v20 offset0:73 offset1:107
    ds_read2st64_b32 v[44:45], v20 offset0:8 offset1:42
    ds_read2st64_b32 v[46:47], v20 offset0:76 offset1:110
    ds_read2st64_b32 v[48:49], v21 offset0:0 offset1:34
    ds_read2st64_b32 v[50:51], v21 offset0:68 offset1:102
    ds_read2st64_b32 v[52:53], v23 offset0:0 offset1:34
    ds_read2st64_b32 v[54:55], v23 offset0:68 offset1:102
    s_waitcnt lgkmcnt(10)
    v_pk_add_f32 v[32:33], v[32:33], v[34:35]
    v_add_f32 v32, v32, v33
    s_waitcnt lgkmcnt(8)
    v_pk_add_f32 v[36:37], v[36:37], v[38:39]
    v_add_f32 v36, v36, v37
    s_waitcnt lgkmcnt(6)
    v_pk_add_f32 v[40:41], v[40:41], v[42:43]
    v_add_f32 v40, v40, v41
    s_waitcnt lgkmcnt(4)
    v_pk_add_f32 v[44:45], v[44:45], v[46:47]
    v_add_f32 v44, v44, v45
    s_waitcnt lgkmcnt(2)
    v_pk_add_f32 v[48:49], v[48:49], v[50:51]
    v_add_f32 v48, v48, v49
    s_waitcnt lgkmcnt(0)
    v_pk_add_f32 v[52:53], v[52:53], v[54:55]
    v_add_f32 v52, v52, v53
    v_cvt_pk_bf16_f32 v68, v32, v32
    v_cvt_pk_bf16_f32 v69, v36, v40
    v_cvt_pk_bf16_f32 v70, v40, v40
    v_cvt_pk_bf16_f32 v71, v44, v48
    ds_write_b128 v29, v[68:71]
    v_cvt_pk_bf16_f32 v73, v32, v36
    v_cvt_pk_bf16_f32 v74, v40, v40
    v_cvt_pk_bf16_f32 v75, v40, v44
    v_cvt_pk_bf16_f32 v72, v52, v32
    s_branch L_k_ej
L_k_e23:
    s_cmp_gt_u32 s45, 3
    s_cbranch_scc1 L_k_e4
    ds_read2st64_b32 v[32:33], v20 offset0:0 offset1:34
    ds_read2st64_b32 v[34:35], v20 offset0:68 offset1:102
    ds_read2st64_b32 v[36:37], v20 offset0:5 offset1:39
    ds_read2st64_b32 v[38:39], v20 offset0:73 offset1:107
    ds_read2st64_b32 v[40:41], v21 offset0:0 offset1:34
    ds_read2st64_b32 v[42:43], v21 offset0:68 offset1:102
    s_waitcnt lgkmcnt(4)
    v_pk_add_f32 v[32:33], v[32:33], v[34:35]
    v_add_f32 v32, v32, v33
    s_waitcnt lgkmcnt(2)
    v_pk_add_f32 v[36:37], v[36:37], v[38:39]
    v_add_f32 v36, v36, v37
    s_waitcnt lgkmcnt(0)
    v_pk_add_f32 v[40:41], v[40:41], v[42:43]
    v_add_f32 v40, v40, v41
    v_cvt_pk_bf16_f32 v68, v32, v32
    v_cvt_pk_bf16_f32 v69, v32, v36
    v_cvt_pk_bf16_f32 v70, v36, v36
    v_cvt_pk_bf16_f32 v71, v40, v40
    ds_write_b128 v29, v[68:71]
    v_cvt_pk_bf16_f32 v73, v32, v32
    v_cvt_pk_bf16_f32 v74, v36, v36
    v_cvt_pk_bf16_f32 v75, v36, v40
    v_cvt_pk_bf16_f32 v72, v32, v32
    s_branch L_k_ej
L_k_e4:
    ds_read2st64_b32 v[32:33], v20 offset0:0 offset1:34
    ds_read2st64_b32 v[34:35], v20 offset0:68 offset1:102
    ds_read2st64_b32 v[36:37], v21 offset0:0 offset1:34
    ds_read2st64_b32 v[38:39], v21 offset0:68 offset1:102
    s_waitcnt lgkmcnt(2)
    v_pk_add_f32 v[32:33], v[32:33], v[34:35]
    v_add_f32 v32, v32, v33
    s_waitcnt lgkmcnt(0)
    v_pk_add_f32 v[36:37], v[36:37], v[38:39]
    v_add_f32 v36, v36, v37
    v_cndmask_b32 v64, v32, v36, s[56:57]
    v_cvt_pk_bf16_f32 v68, v32, v32
    v_cvt_pk_bf16_f32 v69, v32, v32
    v_cvt_pk_bf16_f32 v70, v64, v36
    v_cvt_pk_bf16_f32 v71, v36, v36
    ds_write_b128 v29, v[68:71]
    v_cvt_pk_bf16_f32 v73, v32, v32
    v_cvt_pk_bf16_f32 v74, v32, v64
    v_cvt_pk_bf16_f32 v75, v36, v36
    v_cvt_pk_bf16_f32 v72, v32, v32
L_k_ej:
    ds_write_b128 v29, v[72:75] offset:4160
    s_waitcnt lgkmcnt(0)
    s_barrier
    ds_read2_b32 v[12:13], v0 offset0:0 offset1:1
    ds_read2_b32 v[14:15], v0 offset0:2 offset1:3
    ds_read2_b32 v[16:17], v0 offset0:128 offset1:129
    ds_read2_b32 v[18:19], v0 offset0:130 offset1:131
    ds_read2_b32 v[20:21], v0 offset0:16 offset1:17
    ds_read2_b32 v[22:23], v0 offset0:18 offset1:19
    ds_read2_b32 v[24:25], v0 offset0:144 offset1:145
    ds_read2_b32 v[26:27], v0 offset0:146 offset1:147
    s_barrier
    ds_read_b128 v[32:35], v2 offset:3072
    ds_read_b128 v[40:43], v2 offset:3136
    ds_read_b128 v[48:51], v2 offset:3584
    ds_read2_b32 v[52:53], v3 offset0:0 offset1:1
    s_waitcnt lgkmcnt(3)
    v_mfma_f32_16x16x32_bf16 v[28:31], v[12:15], v[32:35], 0
    ds_read2_b32 v[54:55], v3 offset0:2 offset1:3
    v_mfma_f32_16x16x32_bf16 v[36:39], v[16:19], v[32:35], 0
    ds_read_b128 v[56:59], v2 offset:3648
    s_waitcnt lgkmcnt(4)
    v_mfma_f32_16x16x32_bf16 v[28:31], v[20:23], v[40:43], v[28:31]
    ds_read2_b32 v[60:61], v3 offset0:16 offset1:17
    v_mfma_f32_16x16x32_bf16 v[36:39], v[24:27], v[40:43], v[36:39]
    ds_read2_b32 v[62:63], v3 offset0:18 offset1:19
    s_waitcnt lgkmcnt(5)
    v_mfma_f32_16x16x32_bf16 v[44:47], v[12:15], v[48:51], 0
    ds_read_b128 v[64:67], v2 offset:2560
    v_mfma_f32_16x16x32_bf16 v[28:31], v[16:19], v[48:51], v[28:31]
    ds_read_b128 v[68:71], v2 offset:2624
    s_waitcnt lgkmcnt(5)
    v_mfma_f32_16x16x32_bf16 v[36:39], v[52:55], v[48:51], v[36:39]
    ds_read2_b32 v[80:81], v3 offset0:128 offset1:129
    s_waitcnt lgkmcnt(5)
    v_mfma_f32_16x16x32_bf16 v[44:47], v[20:23], v[56:59], v[44:47]
    ds_read2_b32 v[82:83], v3 offset0:130 offset1:131
    v_mfma_f32_16x16x32_bf16 v[28:31], v[24:27], v[56:59], v[28:31]
    ds_read2_b32 v[84:85], v3 offset0:144 offset1:145
    s_waitcnt lgkmcnt(5)
    v_mfma_f32_16x16x32_bf16 v[36:39], v[60:63], v[56:59], v[36:39]
    ds_read2_b32 v[86:87], v3 offset0:146 offset1:147
    s_waitcnt lgkmcnt(5)
    v_mfma_f32_16x16x32_bf16 v[36:39], v[12:15], v[64:67], v[36:39]
    ds_read_b128 v[88:91], v2 offset:2048
    s_waitcnt lgkmcnt(5)
    v_mfma_f32_16x16x32_bf16 v[36:39], v[20:23], v[68:71], v[36:39]
    ds_read_b128 v[92:95], v2 offset:2112
    v_mfma_f32_16x16x32_bf16 v[72:75], v[16:19], v[64:67], 0
    ds_read2_b32 v[96:97], v4 offset0:0 offset1:1
    v_mfma_f32_16x16x32_bf16 v[76:79], v[52:55], v[64:67], 0
    v_cvt_pk_bf16_f32 v8, v44, v45
    v_cvt_pk_bf16_f32 v9, v46, v47
    v_mfma_f32_16x16x32_bf16 v[72:75], v[24:27], v[68:71], v[72:75]
    ds_write_b64 v6, v[8:9] offset:0
    v_mfma_f32_16x16x32_bf16 v[76:79], v[60:63], v[68:71], v[76:79]
    v_cvt_pk_bf16_f32 v10, v28, v29
    v_cvt_pk_bf16_f32 v11, v30, v31
    v_mfma_f32_16x16x32_bf16 v[72:75], v[52:55], v[32:35], v[72:75]
    ds_write_b64 v6, v[10:11] offset:4608
    s_waitcnt lgkmcnt(7)
    v_mfma_f32_16x16x32_bf16 v[76:79], v[80:83], v[32:35], v[76:79]
    v_cvt_pk_bf16_f32 v8, v36, v37
    v_cvt_pk_bf16_f32 v9, v38, v39
    v_mfma_f32_16x16x32_bf16 v[72:75], v[60:63], v[40:43], v[72:75]
    ds_write_b64 v6, v[8:9] offset:9216
    s_waitcnt lgkmcnt(6)
    v_mfma_f32_16x16x32_bf16 v[76:79], v[84:87], v[40:43], v[76:79]
    ds_read2_b32 v[98:99], v4 offset0:2 offset1:3
    s_waitcnt lgkmcnt(6)
    v_mfma_f32_16x16x32_bf16 v[72:75], v[12:15], v[88:91], v[72:75]
    ds_read2_b32 v[100:101], v4 offset0:16 offset1:17
    v_mfma_f32_16x16x32_bf16 v[76:79], v[16:19], v[88:91], v[76:79]
    s_waitcnt lgkmcnt(2)
    s_barrier
    v_mfma_f32_16x16x32_bf16 v[72:75], v[20:23], v[92:95], v[72:75]
    ds_read2_b32 v[102:103], v4 offset0:18 offset1:19
    v_mfma_f32_16x16x32_bf16 v[76:79], v[24:27], v[92:95], v[76:79]
    ds_read_b128 v[104:107], v2 offset:1536
    v_mfma_f32_16x16x32_bf16 v[72:75], v[80:83], v[48:51], v[72:75]
    ds_read_b128 v[108:111], v2 offset:1600
    s_waitcnt lgkmcnt(4)
    v_mfma_f32_16x16x32_bf16 v[76:79], v[96:99], v[48:51], v[76:79]
    ds_read2_b32 v[116:117], v4 offset0:128 offset1:129
    v_mfma_f32_16x16x32_bf16 v[72:75], v[84:87], v[56:59], v[72:75]
    ds_read2_b32 v[118:119], v4 offset0:130 offset1:131
    s_waitcnt lgkmcnt(4)
    v_mfma_f32_16x16x32_bf16 v[76:79], v[100:103], v[56:59], v[76:79]
    ds_read2_b32 v[120:121], v4 offset0:144 offset1:145
    s_waitcnt lgkmcnt(4)
    v_mfma_f32_16x16x32_bf16 v[76:79], v[12:15], v[104:107], v[76:79]
    ds_read2_b32 v[122:123], v4 offset0:146 offset1:147
    s_waitcnt lgkmcnt(4)
    v_mfma_f32_16x16x32_bf16 v[76:79], v[20:23], v[108:111], v[76:79]
    ds_read_b128 v[124:127], v2 offset:1024
    v_mfma_f32_16x16x32_bf16 v[112:115], v[80:83], v[64:67], 0
    ds_read_b128 v[44:47], v2 offset:1088
    v_mfma_f32_16x16x32_bf16 v[112:115], v[84:87], v[68:71], v[112:115]
    ds_read2_b32 v[36:37], v5 offset0:0 offset1:1
    v_mfma_f32_16x16x32_bf16 v[112:115], v[52:55], v[88:91], v[112:115]
    v_cvt_pk_bf16_f32 v10, v72, v73
    v_cvt_pk_bf16_f32 v11, v74, v75
    v_mfma_f32_16x16x32_bf16 v[112:115], v[60:63], v[92:95], v[112:115]
    ds_write_b64 v6, v[10:11] offset:13824
    v_mfma_f32_16x16x32_bf16 v[112:115], v[96:99], v[32:35], v[112:115]
    ds_read2_b32 v[38:39], v5 offset0:2 offset1:3
    v_mfma_f32_16x16x32_bf16 v[112:115], v[100:103], v[40:43], v[112:115]
    v_cvt_pk_bf16_f32 v8, v76, v77
    v_cvt_pk_bf16_f32 v9, v78, v79
    v_mfma_f32_16x16x32_bf16 v[112:115], v[16:19], v[104:107], v[112:115]
    ds_write_b64 v6, v[8:9] offset:18432
    v_mfma_f32_16x16x32_bf16 v[112:115], v[24:27], v[108:111], v[112:115]
    ds_read2_b32 v[72:73], v5 offset0:16 offset1:17
    s_waitcnt lgkmcnt(9)
    v_mfma_f32_16x16x32_bf16 v[112:115], v[116:119], v[48:51], v[112:115]
    ds_read2_b32 v[74:75], v5 offset0:18 offset1:19
    s_waitcnt lgkmcnt(8)
    v_mfma_f32_16x16x32_bf16 v[112:115], v[120:123], v[56:59], v[112:115]
    s_waitcnt lgkmcnt(2)
    s_barrier
    v_mfma_f32_16x16x32_bf16 v[112:115], v[12:15], v[124:127], v[112:115]
    ds_read_b128 v[76:79], v2 offset:512
    v_mfma_f32_16x16x32_bf16 v[112:115], v[20:23], v[44:47], v[112:115]
    v_mfma_f32_16x16x32_bf16 v[28:31], v[80:83], v[88:91], 0
    v_mfma_f32_16x16x32_bf16 v[28:31], v[84:87], v[92:95], v[28:31]
    v_mfma_f32_16x16x32_bf16 v[28:31], v[96:99], v[64:67], v[28:31]
    v_mfma_f32_16x16x32_bf16 v[28:31], v[100:103], v[68:71], v[28:31]
    v_mfma_f32_16x16x32_bf16 v[28:31], v[52:55], v[104:107], v[28:31]
    v_mfma_f32_16x16x32_bf16 v[28:31], v[60:63], v[108:111], v[28:31]
    s_nop 1
    v_cvt_pk_bf16_f32 v10, v112, v113
    v_cvt_pk_bf16_f32 v11, v114, v115
    v_mfma_f32_16x16x32_bf16 v[28:31], v[116:119], v[32:35], v[28:31]
    ds_write_b64 v6, v[10:11] offset:23040
    v_mfma_f32_16x16x32_bf16 v[28:31], v[120:123], v[40:43], v[28:31]
    ds_read_b128 v[112:115], v2 offset:576
    v_mfma_f32_16x16x32_bf16 v[28:31], v[16:19], v[124:127], v[28:31]
    v_mfma_f32_16x16x32_bf16 v[28:31], v[24:27], v[44:47], v[28:31]
    s_waitcnt lgkmcnt(1)
    s_barrier
    v_mfma_f32_16x16x32_bf16 v[28:31], v[36:39], v[48:51], v[28:31]
    v_mfma_f32_16x16x32_bf16 v[28:31], v[72:75], v[56:59], v[28:31]
    v_mfma_f32_16x16x32_bf16 v[28:31], v[12:15], v[76:79], v[28:31]
    s_waitcnt lgkmcnt(0)
    v_mfma_f32_16x16x32_bf16 v[28:31], v[20:23], v[112:115], v[28:31]
    v_mfma_f32_16x16x32_bf16 v[12:15], v[96:99], v[88:91], 0
    ds_read2_b32 v[88:89], v5 offset0:128 offset1:129
    v_mfma_f32_16x16x32_bf16 v[12:15], v[100:103], v[92:95], v[12:15]
    ds_read2_b32 v[90:91], v5 offset0:130 offset1:131
    v_mfma_f32_16x16x32_bf16 v[12:15], v[80:83], v[104:107], v[12:15]
    ds_read2_b32 v[92:93], v5 offset0:144 offset1:145
    v_mfma_f32_16x16x32_bf16 v[12:15], v[84:87], v[108:111], v[12:15]
    ds_read2_b32 v[94:95], v5 offset0:146 offset1:147
    v_mfma_f32_16x16x32_bf16 v[12:15], v[116:119], v[64:67], v[12:15]
    ds_read_b128 v[108:111], v2 offset:0
    v_mfma_f32_16x16x32_bf16 v[12:15], v[120:123], v[68:71], v[12:15]
    v_cvt_pk_bf16_f32 v8, v28, v29
    v_cvt_pk_bf16_f32 v9, v30, v31
    v_mfma_f32_16x16x32_bf16 v[12:15], v[52:55], v[124:127], v[12:15]
    ds_write_b64 v6, v[8:9] offset:27648
    v_mfma_f32_16x16x32_bf16 v[12:15], v[60:63], v[44:47], v[12:15]
    ds_read2_b32 v[28:29], v0 offset0:0 offset1:1
    v_mfma_f32_16x16x32_bf16 v[12:15], v[36:39], v[32:35], v[12:15]
    ds_read2_b32 v[30:31], v0 offset0:2 offset1:3
    v_mfma_f32_16x16x32_bf16 v[12:15], v[72:75], v[40:43], v[12:15]
    s_waitcnt lgkmcnt(2)
    s_barrier
    v_mfma_f32_16x16x32_bf16 v[12:15], v[16:19], v[76:79], v[12:15]
    ds_read_b128 v[44:47], v2 offset:64
    v_mfma_f32_16x16x32_bf16 v[12:15], v[24:27], v[112:115], v[12:15]
    v_mfma_f32_16x16x32_bf16 v[12:15], v[88:91], v[48:51], v[12:15]
    v_mfma_f32_16x16x32_bf16 v[12:15], v[92:95], v[56:59], v[12:15]
    s_waitcnt lgkmcnt(1)
    v_mfma_f32_16x16x32_bf16 v[12:15], v[28:31], v[108:111], v[12:15]
    s_waitcnt lgkmcnt(0)
    v_mfma_f32_16x16x32_bf16 v[12:15], v[20:23], v[44:47], v[12:15]
    s_nop 7
    v_cvt_pk_bf16_f32 v10, v12, v13
    v_cvt_pk_bf16_f32 v11, v14, v15
    ds_write_b64 v6, v[10:11] offset:32256
    s_waitcnt lgkmcnt(0)
    s_barrier
    s_endpgm
L_ffn:
    s_cmp_ge_u32 s2, 252
    s_cselect_b32 s45, 15, s40
    s_cmp_lg_u32 s45, 15
    s_cbranch_scc1 L_f_go
    s_endpgm
L_f_go:
    s_min_u32 s41, s43, 4
    s_mul_i32 s45, s43, 3
    s_add_u32 s41, s41, s45
    s_add_u32 s41, s41, s44
    s_sub_u32 s41, s41, 28
    v_and_b32 v3, 15, v1
    v_lshrrev_b32 v4, 4, v1
    v_lshrrev_b32 v5, 3, v3
    v_lshl_add_u32 v7, v5, 2, v4
    v_mul_u32_u24 v5, 28672, v7
    v_and_b32 v6, 7, v3
    v_lshl_add_u32 v5, v6, 4, v5
    s_sub_u32 s53, s40, 1
    s_lshr_b32 s56, s53, 1
    s_mul_i32 s44, s56, 229376
    s_lshl_b32 s45, s41, 7
    s_add_u32 s44, s44, s45
    s_add_u32 s45, s44, 7168
    s_add_u32 s46, s44, 14336
    s_add_u32 s47, s44, 21504
    s_and_b32 s57, s53, 1
    s_waitcnt lgkmcnt(0)
    s_load_dword s42, s[34:35], 0
    s_cselect_b64 s[8:9], s[24:25], s[22:23]
    s_mov_b32 s10, 1605632
    s_mov_b32 s11, 0x20000
    s_cmp_eq_u32 s40, 0
    s_cbranch_scc1 L_f_nogu
    buffer_load_dwordx4 v[32:35], v5, s[8:11], s44 offen offset:0
    buffer_load_dwordx4 v[36:39], v5, s[8:11], s44 offen offset:3584
    buffer_load_dwordx4 v[40:43], v5, s[8:11], s45 offen offset:0
    buffer_load_dwordx4 v[44:47], v5, s[8:11], s45 offen offset:3584
    buffer_load_dwordx4 v[48:51], v5, s[8:11], s46 offen offset:0
    buffer_load_dwordx4 v[52:55], v5, s[8:11], s46 offen offset:3584
    buffer_load_dwordx4 v[56:59], v5, s[8:11], s47 offen offset:0
    buffer_load_dwordx4 v[60:63], v5, s[8:11], s47 offen offset:3584
L_f_nogu:
    s_mov_b64 s[12:13], s[26:27]
    s_mov_b32 s14, 1605632
    s_mov_b32 s15, 0x20000
    s_mov_b64 s[36:37], s[34:35]
    s_mov_b32 s38, 16777216
    s_mov_b32 s39, 0x20000
    v_mul_u32_u24 v8, 7168, v7
    v_lshl_add_u32 v8, v6, 4, v8
    s_mul_i32 s48, s41, 57344
    s_lshl_b32 s49, s53, 7
    s_add_u32 s48, s48, s49
    s_add_u32 s49, s48, 3584
    s_mul_i32 s52, s41, 3712
    s_lshl_b32 s50, s53, 9
    s_add_u32 s52, s52, s50
    s_add_u32 s52, s52, 32768
    s_mov_b32 s54, 0x05040100
    s_mov_b32 s55, 0x07060302
    v_and_b32 v14, 1, v3
    v_lshlrev_b32 v14, 6, v14
    v_lshl_add_u32 v14, v4, 4, v14
    s_lshl_b32 s44, s56, 7
    v_add_u32 v14, s44, v14
    v_lshl_add_u32 v10, v6, 2, v4
    v_lshlrev_b32 v10, 4, v10
    s_lshl_b32 s44, s56, 9
    s_lshl_b32 s45, s57, 2
    s_add_u32 s44, s44, s45
    s_add_u32 s44, s44, 1024
    v_add_u32 v15, s44, v10
    v_lshl_add_u32 v10, v4, 3, v6
    v_lshlrev_b32 v10, 4, v10
    v_lshl_add_u32 v16, v7, 3, v6
    v_lshlrev_b32 v16, 3, v16
    v_mov_b32 v17, 5120
    s_waitcnt lgkmcnt(0)
    s_mul_i32 s42, s42, 0x9e3779b1
    s_add_u32 s42, s42, 0x7f4a7c15
    s_bitset1_b32 s42, 0
    s_cmp_eq_u32 s40, 0
    s_cbranch_scc1 L_f_router
    s_cmp_le_u32 s40, 12
    s_cbranch_scc1 L_f_e0
    s_barrier
L_f_e0:
    s_waitcnt vmcnt(0)
    v_perm_b32 v64, v36, v32, s54
    v_perm_b32 v68, v36, v32, s55
    v_perm_b32 v72, v37, v33, s54
    v_perm_b32 v76, v37, v33, s55
    v_perm_b32 v80, v38, v34, s54
    v_perm_b32 v84, v38, v34, s55
    v_perm_b32 v88, v39, v35, s54
    v_perm_b32 v92, v39, v35, s55
    v_perm_b32 v65, v44, v40, s54
    v_perm_b32 v69, v44, v40, s55
    v_perm_b32 v73, v45, v41, s54
    v_perm_b32 v77, v45, v41, s55
    v_perm_b32 v81, v46, v42, s54
    v_perm_b32 v85, v46, v42, s55
    v_perm_b32 v89, v47, v43, s54
    v_perm_b32 v93, v47, v43, s55
    v_perm_b32 v66, v52, v48, s54
    v_perm_b32 v70, v52, v48, s55
    v_perm_b32 v74, v53, v49, s54
    v_perm_b32 v78, v53, v49, s55
    v_perm_b32 v82, v54, v50, s54
    v_perm_b32 v86, v54, v50, s55
    v_perm_b32 v90, v55, v51, s54
    v_perm_b32 v94, v55, v51, s55
    v_perm_b32 v67, v60, v56, s54
    v_perm_b32 v71, v60, v56, s55
    v_perm_b32 v75, v61, v57, s54
    v_perm_b32 v79, v61, v57, s55
    v_perm_b32 v83, v62, v58, s54
    v_perm_b32 v87, v62, v58, s55
    v_perm_b32 v91, v63, v59, s54
    v_perm_b32 v95, v63, v59, s55
    s_cmp_gt_u32 s40, 12
    s_cbranch_scc1 L_f_e1
    s_barrier
    s_cmp_gt_u32 s40, 7
    s_cbranch_scc1 L_f_e1
    buffer_load_dwordx4 v[96:99], v8, s[12:15], s48 offen offset:0
    buffer_load_dwordx4 v[100:103], v8, s[12:15], s48 offen offset:896
L_f_e1:
    s_barrier
    s_cmp_gt_u32 s40, 7
    s_cbranch_scc1 L_f_join
    buffer_load_dwordx4 v[104:107], v8, s[12:15], s48 offen offset:1792
    buffer_load_dwordx4 v[108:111], v8, s[12:15], s48 offen offset:2688
    buffer_load_dwordx4 v[112:115], v8, s[12:15], s49 offen offset:0
    buffer_load_dwordx4 v[116:119], v8, s[12:15], s49 offen offset:896
    buffer_load_dwordx4 v[120:123], v8, s[12:15], s49 offen offset:1792
    buffer_load_dwordx4 v[124:127], v8, s[12:15], s49 offen offset:2688
    s_branch L_f_join
L_f_router:
    s_setprio 3
    v_lshlrev_b32 v18, 4, v1
    s_mov_b32 s44, 20480
    s_mov_b32 s46, 0
    s_barrier
L_f_kpoll:
    buffer_load_dwordx4 v[32:35], v18, s[36:39], s44 offen offset:0 sc1
    buffer_load_dwordx4 v[36:39], v18, s[36:39], s44 offen offset:1024 sc1
    buffer_load_dwordx4 v[40:43], v18, s[36:39], s44 offen offset:2048 sc1
    buffer_load_dwordx4 v[44:47], v18, s[36:39], s44 offen offset:3072 sc1
    v_mov_b32 v19, 0
    v_mov_b32 v20, 0
    s_waitcnt vmcnt(3)
    v_bitop3_b32 v19, v33, s42, v19 bitop3:0xbe
    v_max3_u32 v20, v32, v34, v20
    v_bitop3_b32 v19, v35, s42, v19 bitop3:0xbe
    s_waitcnt vmcnt(2)
    v_bitop3_b32 v19, v37, s42, v19 bitop3:0xbe
    v_max3_u32 v20, v36, v38, v20
    v_bitop3_b32 v19, v39, s42, v19 bitop3:0xbe
    s_waitcnt vmcnt(1)
    v_bitop3_b32 v19, v41, s42, v19 bitop3:0xbe
    v_max3_u32 v20, v40, v42, v20
    v_bitop3_b32 v19, v43, s42, v19 bitop3:0xbe
    s_waitcnt vmcnt(0)
    v_bitop3_b32 v19, v45, s42, v19 bitop3:0xbe
    v_max3_u32 v20, v44, v46, v20
    v_bitop3_b32 v19, v47, s42, v19 bitop3:0xbe
    v_cmp_ne_u32 vcc, 0, v19
    s_cbranch_vccz L_f_kpolled
    s_add_u32 s46, s46, 1
    s_cmp_ge_u32 s46, 200000
    s_cbranch_scc1 L_f_kpolled
    s_mov_b64 exec, vcc
    s_branch L_f_kpoll
L_f_kpolled:
    s_mov_b64 exec, -1
    v_max_u32_dpp v20, v20, v20 row_shr:1 row_mask:0xf bank_mask:0xf
    s_nop 1
    v_max_u32_dpp v20, v20, v20 row_shr:2 row_mask:0xf bank_mask:0xf
    s_nop 1
    v_max_u32_dpp v20, v20, v20 row_shr:4 row_mask:0xf bank_mask:0xf
    s_nop 1
    v_max_u32_dpp v20, v20, v20 row_shr:8 row_mask:0xf bank_mask:0xf
    s_nop 1
    v_max_u32_dpp v20, v20, v20 row_bcast:15 row_mask:0xa bank_mask:0xf
    s_nop 1
    v_max_u32_dpp v20, v20, v20 row_bcast:31 row_mask:0xc bank_mask:0xf
    s_nop 0
    v_readlane_b32 s44, v20, 63
    s_mov_b32 exec_hi, 0xffffff
    s_and_b32 s45, s44, 0x7ff
    s_sub_u32 s45, 2047, s45
    s_mul_i32 s46, s45, 896
    buffer_load_dwordx4 v[32:35], v18, s[4:7], s46 offen
    s_lshr_b32 s47, s45, 2
    s_lshl_b32 s47, s47, 4
    s_bfe_u32 s56, s45, 0x10001
    s_lshl_b32 s56, s56, 13
    s_add_u32 s47, s47, s56
    s_add_u32 s47, s47, 4096
    s_mov_b32 s46, 0
    buffer_load_dwordx4 v[36:39], off, s[36:39], s47 sc1
    v_mov_b32 v22, s45
    v_mov_b32 v23, s42
    s_cmp_eq_u32 s41, 0
    s_cselect_b32 s56, 2048, s38
    s_mov_b64 exec, 1
    buffer_store_dwordx2 v[22:23], off, s[36:39], s56 sc1
    s_mov_b32 exec_lo, -1
    s_mov_b32 exec_hi, 0xffffff
    s_barrier
    s_ashr_i32 s56, s44, 31
    s_not_b32 s56, s56
    s_or_b32 s56, s56, 0x80000000
    s_xor_b32 s56, s56, s44
    s_and_b32 s56, s56, 0xffff0000
    v_mov_b32 v21, 0xbfb8aa3b
    v_mul_f32 v21, s56, v21
    v_exp_f32 v21, v21
    s_nop 0
    v_add_f32 v21, 1.0, v21
    v_rcp_f32 v21, v21
    s_nop 0
    ds_write_b32 v17, v21
    s_waitcnt vmcnt(1)
L_f_spoll:
    v_cmp_ne_u32 vcc, s42, v39
    s_cbranch_vccz L_f_spolled
    s_add_u32 s46, s46, 1
    s_cmp_ge_u32 s46, 200000
    s_cbranch_scc1 L_f_spolled
    buffer_load_dwordx4 v[36:39], off, s[36:39], s47 sc1
    s_waitcnt vmcnt(0)
    s_branch L_f_spoll
L_f_spolled:
    s_bitcmp1_b32 s45, 0
    s_cselect_b64 vcc, -1, 0
    v_lshlrev_b32 v40, 16, v38
    v_and_b32 v41, 0xffff0000, v38
    v_cndmask_b32 v36, v36, v37, vcc
    v_cndmask_b32 v37, v40, v41, vcc
    v_lshlrev_b32 v40, 16, v32
    v_and_b32 v41, 0xffff0000, v32
    v_lshlrev_b32 v42, 16, v33
    v_and_b32 v43, 0xffff0000, v33
    v_lshlrev_b32 v44, 16, v34
    v_and_b32 v45, 0xffff0000, v34
    v_lshlrev_b32 v46, 16, v35
    v_and_b32 v47, 0xffff0000, v35
    v_pk_add_f32 v[40:41], v[40:41], v[36:37] op_sel:[0,1] op_sel_hi:[1,1] neg_lo:[0,1] neg_hi:[0,1]
    v_pk_add_f32 v[42:43], v[42:43], v[36:37] op_sel:[0,1] op_sel_hi:[1,1] neg_lo:[0,1] neg_hi:[0,1]
    v_pk_add_f32 v[44:45], v[44:45], v[36:37] op_sel:[0,1] op_sel_hi:[1,1] neg_lo:[0,1] neg_hi:[0,1]
    v_pk_add_f32 v[46:47], v[46:47], v[36:37] op_sel:[0,1] op_sel_hi:[1,1] neg_lo:[0,1] neg_hi:[0,1]
    v_pk_mul_f32 v[40:41], v[40:41], v[36:37] op_sel:[0,0] op_sel_hi:[1,0]
    v_pk_mul_f32 v[42:43], v[42:43], v[36:37] op_sel:[0,0] op_sel_hi:[1,0]
    v_pk_mul_f32 v[44:45], v[44:45], v[36:37] op_sel:[0,0] op_sel_hi:[1,0]
    v_pk_mul_f32 v[46:47], v[46:47], v[36:37] op_sel:[0,0] op_sel_hi:[1,0]
    v_cvt_pk_bf16_f32 v32, v40, v41
    v_cvt_pk_bf16_f32 v33, v42, v43
    v_cvt_pk_bf16_f32 v34, v44, v45
    v_cvt_pk_bf16_f32 v35, v46, v47
    ds_write_b128 v18, v[32:35] offset:0
    s_mov_b64 exec, -1
    s_waitcnt lgkmcnt(0)
L_f_join:
    s_barrier
    s_cmp_eq_u32 s40, 0
    s_cbranch_scc1 L_exit
    ds_read_b128 v[20:23], v14 offset:0
    s_waitcnt lgkmcnt(0)
    v_mfma_f32_16x16x32_bf16 v[32:35], v[20:23], v[64:67], 0
    v_mfma_f32_16x16x32_bf16 v[36:39], v[20:23], v[68:71], 0
    v_mfma_f32_16x16x32_bf16 v[40:43], v[20:23], v[72:75], 0
    v_mfma_f32_16x16x32_bf16 v[44:47], v[20:23], v[76:79], 0
    v_mfma_f32_16x16x32_bf16 v[48:51], v[20:23], v[80:83], 0
    v_mfma_f32_16x16x32_bf16 v[52:55], v[20:23], v[84:87], 0
    v_mfma_f32_16x16x32_bf16 v[56:59], v[20:23], v[88:91], 0
    v_mfma_f32_16x16x32_bf16 v[60:63], v[20:23], v[92:95], 0
    s_nop 0
    v_add_f32_dpp v4, v33, v32 row_ror:8 row_mask:0x1 bank_mask:0xf
    v_add_f32_dpp v5, v37, v36 row_ror:8 row_mask:0x1 bank_mask:0xf
    s_nop 0
    v_add_f32_dpp v4, v41, v40 row_ror:8 row_mask:0x2 bank_mask:0xf
    v_add_f32_dpp v5, v45, v44 row_ror:8 row_mask:0x2 bank_mask:0xf
    s_nop 0
    v_add_f32_dpp v4, v49, v48 row_ror:8 row_mask:0x4 bank_mask:0xf
    v_add_f32_dpp v5, v53, v52 row_ror:8 row_mask:0x4 bank_mask:0xf
    s_nop 0
    v_add_f32_dpp v4, v57, v56 row_ror:8 row_mask:0x8 bank_mask:0xf
    v_add_f32_dpp v5, v61, v60 row_ror:8 row_mask:0x8 bank_mask:0xf
    s_mov_b32 exec_lo, 0x00ff00ff
    s_mov_b32 exec_hi, 0x00ff00ff
    ds_write2_b32 v15, v4, v5 offset0:0 offset1:2
    s_mov_b64 exec, -1
    s_cmp_gt_u32 s40, 7
    s_cbranch_scc1 L_f_nogu2
    ds_read_b32 v31, v17
    v_mov_b32 v7, s42
    s_waitcnt vmcnt(0)
    v_perm_b32 v64, v100, v96, s54
    v_perm_b32 v68, v100, v96, s55
    v_perm_b32 v72, v101, v97, s54
    v_perm_b32 v76, v101, v97, s55
    v_perm_b32 v80, v102, v98, s54
    v_perm_b32 v84, v102, v98, s55
    v_perm_b32 v88, v103, v99, s54
    v_perm_b32 v92, v103, v99, s55
    v_perm_b32 v65, v108, v104, s54
    v_perm_b32 v69, v108, v104, s55
    v_perm_b32 v73, v109, v105, s54
    v_perm_b32 v77, v109, v105, s55
    v_perm_b32 v81, v110, v106, s54
    v_perm_b32 v85, v110, v106, s55
    v_perm_b32 v89, v111, v107, s54
    v_perm_b32 v93, v111, v107, s55
    v_perm_b32 v66, v116, v112, s54
    v_perm_b32 v70, v116, v112, s55
    v_perm_b32 v74, v117, v113, s54
    v_perm_b32 v78, v117, v113, s55
    v_perm_b32 v82, v118, v114, s54
    v_perm_b32 v86, v118, v114, s55
    v_perm_b32 v90, v119, v115, s54
    v_perm_b32 v94, v119, v115, s55
    v_perm_b32 v67, v124, v120, s54
    v_perm_b32 v71, v124, v120, s55
    v_perm_b32 v75, v125, v121, s54
    v_perm_b32 v79, v125, v121, s55
    v_perm_b32 v83, v126, v122, s54
    v_perm_b32 v87, v126, v122, s55
    v_perm_b32 v91, v127, v123, s54
    v_perm_b32 v95, v127, v123, s55
L_f_nogu2:
    s_waitcnt lgkmcnt(0)
    s_barrier
    s_cmp_gt_u32 s53, 6
    s_cbranch_scc1 L_f_end
    ds_read_b64 v[32:33], v16 offset:1024
    ds_read_b64 v[34:35], v16 offset:1536
    ds_read_b64 v[36:37], v16 offset:2048
    ds_read_b64 v[38:39], v16 offset:2560
    ds_read_b64 v[40:41], v16 offset:3072
    ds_read_b64 v[42:43], v16 offset:3584
    ds_read_b64 v[44:45], v16 offset:4096
    s_waitcnt lgkmcnt(5)
    v_pk_add_f32 v[32:33], v[32:33], v[34:35]
    s_waitcnt lgkmcnt(3)
    v_pk_add_f32 v[36:37], v[36:37], v[38:39]
    s_waitcnt lgkmcnt(1)
    v_pk_add_f32 v[40:41], v[40:41], v[42:43]
    v_pk_add_f32 v[32:33], v[32:33], v[36:37]
    s_waitcnt lgkmcnt(0)
    v_pk_add_f32 v[40:41], v[40:41], v[44:45]
    v_pk_add_f32 v[32:33], v[32:33], v[40:41]
    v_mul_f32 v34, 0xbfb8aa3b, v32
    v_exp_f32 v34, v34
    v_mul_f32 v32, v32, v33
    v_add_f32 v34, 1.0, v34
    v_rcp_f32 v34, v34
    v_mul_f32 v32, v32, v31
    v_mul_f32 v32, v32, v34
    s_nop 1
    v_mov_b32_dpp v33, v32 quad_perm:[0,0,2,2] row_mask:0xf bank_mask:0xf
    v_mov_b32_dpp v34, v32 quad_perm:[1,1,3,3] row_mask:0xf bank_mask:0xf
    v_cvt_pk_bf16_f32 v32, v33, v34
    s_nop 1
    v_mov_b32_dpp v20, v32 row_newbcast:0 row_mask:0xf bank_mask:0xf
    v_mov_b32_dpp v21, v32 row_newbcast:2 row_mask:0xf bank_mask:0xf
    v_mov_b32_dpp v22, v32 row_newbcast:4 row_mask:0xf bank_mask:0xf
    v_mov_b32_dpp v23, v32 row_newbcast:6 row_mask:0xf bank_mask:0xf
    s_mov_b32 exec_lo, 0xaaaaaaaa
    s_mov_b32 exec_hi, 0xaaaaaaaa
    v_mov_b32_dpp v20, v32 row_newbcast:9 row_mask:0xf bank_mask:0xf
    v_mov_b32_dpp v21, v32 row_newbcast:11 row_mask:0xf bank_mask:0xf
    v_mov_b32_dpp v22, v32 row_newbcast:13 row_mask:0xf bank_mask:0xf
    v_mov_b32_dpp v23, v32 row_newbcast:15 row_mask:0xf bank_mask:0xf
    s_mov_b64 exec, -1
    s_nop 0
    v_mfma_f32_16x16x32_bf16 v[96:99], v[20:23], v[64:67], 0
    v_mfma_f32_16x16x32_bf16 v[100:103], v[20:23], v[68:71], 0
    v_mfma_f32_16x16x32_bf16 v[104:107], v[20:23], v[72:75], 0
    v_mfma_f32_16x16x32_bf16 v[108:111], v[20:23], v[76:79], 0
    v_mfma_f32_16x16x32_bf16 v[112:115], v[20:23], v[80:83], 0
    v_mfma_f32_16x16x32_bf16 v[116:119], v[20:23], v[84:87], 0
    v_mfma_f32_16x16x32_bf16 v[120:123], v[20:23], v[88:91], 0
    v_mfma_f32_16x16x32_bf16 v[124:127], v[20:23], v[92:95], 0
    s_nop 0
    v_add_f32_dpp v4, v97, v96 row_ror:8 row_mask:0x1 bank_mask:0xf
    v_add_f32_dpp v5, v101, v100 row_ror:8 row_mask:0x1 bank_mask:0xf
    s_nop 0
    v_add_f32_dpp v4, v105, v104 row_ror:8 row_mask:0x2 bank_mask:0xf
    v_add_f32_dpp v5, v109, v108 row_ror:8 row_mask:0x2 bank_mask:0xf
    s_nop 0
    v_add_f32_dpp v4, v113, v112 row_ror:8 row_mask:0x4 bank_mask:0xf
    v_add_f32_dpp v5, v117, v116 row_ror:8 row_mask:0x4 bank_mask:0xf
    s_nop 0
    v_add_f32_dpp v4, v121, v120 row_ror:8 row_mask:0x8 bank_mask:0xf
    v_add_f32_dpp v5, v125, v124 row_ror:8 row_mask:0x8 bank_mask:0xf
    s_mov_b32 exec_lo, 0x00ff00ff
    s_mov_b32 exec_hi, 0x00ff00ff
    buffer_store_dwordx4 v[4:7], v10, s[36:39], s52 offen sc1
L_f_end:
    s_endpgm
L_exit:
    s_endpgm
.section .rodata,"a"
.p2align 6
.amdhsa_kernel parallel_sum__ssm_conv_s4d__moe_arch_mod__prompt_kernel
  .amdhsa_next_free_vgpr 128
  .amdhsa_next_free_sgpr 64
  .amdhsa_accum_offset 128
  .amdhsa_group_segment_fixed_size 0
  .amdhsa_kernarg_size 120
  .amdhsa_user_sgpr_count 2
  .amdhsa_user_sgpr_kernarg_segment_ptr 1
  .amdhsa_system_sgpr_workgroup_id_x 1
.end_amdhsa_kernel
```
